```python
import torch

def _softmax(x, axis=-1):
    return torch.softmax(x, dim=axis)
def _gelu(x):
    return torch.nn.functional.gelu(x, approximate="tanh")
def _silu(x):
    return torch.nn.functional.silu(x)
def _sigmoid(x):
    return torch.sigmoid(x)
def _layernorm(x, axis=-1, eps=1e-5):
    m = x.mean(dim=axis, keepdim=True)
    v = x.var(dim=axis, keepdim=True, unbiased=False)
    return (x - m) / torch.sqrt(v + eps)
def _scatter_add(tgt, idx, src, axis=0):
    return tgt.clone().index_add_(axis, idx, src)
def _segment_sum(src, seg, n):
    out = torch.zeros((n,) + src.shape[1:], dtype=src.dtype)
    return out.index_add_(0, seg, src)
def _pad(x, pw):
    flat = tuple(v for pair in reversed(pw) for v in pair)
    return torch.nn.functional.pad(x, flat)

kernel_name = 'sequential_preLN__ssm_conv_s4d__mixer_s_mlp__prompt'

def setup_inputs():

    _w = (lambda a: (lambda t: t.to(torch.bfloat16) if t.is_floating_point() else t)(torch.as_tensor(a)))
    def _A_setup():
        Bsz, L, D, N = 1, 2048, 448, 256
        return {
            "u": _w((lambda *s: torch.randn(*s, dtype=torch.bfloat16) * 0.05)(Bsz, L, D)),
            "log_A_real": _w((lambda *s: torch.randn(*s, dtype=torch.bfloat16) * 6.4)(D, N) * 0.5),
            "A_imag": _w((lambda *s: torch.randn(*s, dtype=torch.bfloat16) * 0.05)(D, N) * 3.14),
            "C_real": _w((lambda *s: torch.randn(*s, dtype=torch.bfloat16) * 0.05)(D, N) / N ** 0.5),
            "C_imag": _w((lambda *s: torch.randn(*s, dtype=torch.bfloat16) * 0.05)(D, N) / N ** 0.5),
            "log_dt": _w((lambda *s: torch.randn(*s, dtype=torch.bfloat16) * 0.05)(D) * 0.5 - 4.0),
            "D_skip": _w((lambda *s: torch.randn(*s, dtype=torch.bfloat16) * 0.05)(D)),
        }
    _A_in = _A_setup()

    def _B_setup():
        B, S, D, F = 1, 2048, 448, 1792
        return {
            "x":  _w((lambda *s: torch.randn(*s, dtype=torch.bfloat16) * 0.05)(B, S, D)),
            "w1": _w((lambda *s: torch.randn(*s, dtype=torch.bfloat16) * 6.4)(D, D) * (D ** -0.5)),
            "w2": _w((lambda *s: torch.randn(*s, dtype=torch.bfloat16) * 6.4)(D, D) * (D ** -0.5)),
            "w3": _w((lambda *s: torch.randn(*s, dtype=torch.bfloat16) * 6.4)(D, F) * (D ** -0.5)),
            "w4": _w((lambda *s: torch.randn(*s, dtype=torch.bfloat16) * 3.2)(F, D) * (F ** -0.5)),
        }
    _B_in = _B_setup()

    return {
        "A_u": _A_in["u"],
        "A_log_A_real": _A_in["log_A_real"],
        "A_A_imag": _A_in["A_imag"],
        "A_C_real": _A_in["C_real"],
        "A_C_imag": _A_in["C_imag"],
        "A_log_dt": _A_in["log_dt"],
        "A_D_skip": _A_in["D_skip"],
        "B_x": _B_in["x"],
        "B_w1": _B_in["w1"],
        "B_w2": _B_in["w2"],
        "B_w3": _B_in["w3"],
        "B_w4": _B_in["w4"],
    }

def reference(A_u, A_log_A_real, A_A_imag, A_C_real, A_C_imag, A_log_dt, A_D_skip, B_x, B_w1, B_w2, B_w3, B_w4):
    def _A_ref(u, log_A_real, A_imag, C_real, C_imag, log_dt, D_skip):
        L = u.shape[1]
        dt = torch.exp(log_dt)
        A = -torch.exp(log_A_real) + 1j * A_imag
        C = (C_real + 1j * C_imag) * dt[:, None]
        pos = (lambda x, dt: x.to(dt))(torch.arange(L), log_dt.dtype)
        P = torch.exp((A * dt[:, None])[:, :, None] * pos[None, None, :])
        K = 2.0 * torch.einsum("dn,dnl->dl", C, P).real
        L2 = 2 * L
        u_t = (lambda x, *d: x.permute(*d))(u, 0, 2, 1)
        Kf = (lambda x, *a, **k: torch.fft.rfft(x.float(), *a, **k))(K, L2)
        Uf = (lambda x, *a, **k: torch.fft.rfft(x.float(), *a, **k))(u_t, L2)
        y = (lambda x, *a, **k: torch.fft.irfft(x, *a, **k).to(torch.bfloat16))(Uf * Kf[None, :, :], L2)[:, :, :L]
        y = (lambda x, *d: x.permute(*d))(y, 0, 2, 1)
        return y + u * D_skip[None, None, :]

    def _B_ref(x, w1, w2, w3, w4):
        B, S, D = x.shape
        h = _gelu(_layernorm(x, axis=-1) @ w1)
        c = D // 4
        g0 = _pad(h[:, :, 0*c:1*c], ((0, 0), (1, 0), (0, 0)))[:, :S, :]
        g1 = _pad(h[:, :, 1*c:2*c], ((0, 0), (0, 1), (0, 0)))[:, 1:, :]
        g2 = _pad(h[:, :, 2*c:3*c], ((0, 0), (2, 0), (0, 0)))[:, :S, :]
        g3 = _pad(h[:, :, 3*c:   ], ((0, 0), (0, 2), (0, 0)))[:, 2:, :]
        hs = torch.concatenate([g0, g1, g2, g3], axis=-1) @ w2
        x1 = x + hs
        h2 = _gelu(_layernorm(x1, axis=-1) @ w3) @ w4
        return x1 + h2

    x = A_u
    h = x + _A_ref(_layernorm(x, axis=-1), A_log_A_real, A_A_imag, A_C_real, A_C_imag, A_log_dt, A_D_skip)
    h2 = h + _B_ref(_layernorm(h, axis=-1), B_w1, B_w2, B_w3, B_w4)
    return h2
```

```asm
; @launch grid=(256,1,1) block=(256,1,1) lds=163840
.amdgcn_target "amdgcn-amd-amdhsa--gfx950"
.text
.globl sequential_preLN__ssm_conv_s4d__mixer_s_mlp__prompt_kernel
.p2align 12
.p2align 8
.type sequential_preLN__ssm_conv_s4d__mixer_s_mlp__prompt_kernel,@function
sequential_preLN__ssm_conv_s4d__mixer_s_mlp__prompt_kernel:
    s_cmp_ge_u32 s2, 256
    s_cbranch_scc1 K_END
    s_load_dwordx16 s[4:19], s[0:1], 0
    s_load_dwordx8 s[20:27], s[0:1], 64
    s_load_dwordx4 s[28:31], s[0:1], 96
    s_load_dwordx2 s[32:33], s[0:1], 112
    s_cmp_lt_u32 s2, 32
    s_cbranch_scc1 K_LN
    s_getpc_b64 s[46:47]
    s_lshr_b32 s3, s2, 3
    s_sub_u32 s3, s3, 4
    s_mul_i32 s52, s3, 9
    v_min_u32 v2, 8, v0
    v_add_u32 v2, s52, v2
    v_min_u32 v2, 243, v2
    v_lshlrev_b32 v2, 7, v2
    global_load_dword v255, v2, s[46:47]
    v_lshrrev_b32 v2, 6, v0
    v_and_b32 v1, 63, v0
    v_readfirstlane_b32 s34, v2
    s_mov_b32 s38, 19849216
    s_mov_b32 s39, 0x20000
    s_and_b32 s44, s2, 7
    v_lshrrev_b32 v7, 3, v1
    v_and_b32 v17, 7, v1
    v_lshlrev_b32 v9, 4, v17
    v_mul_u32_u24 v16, 896, v7
    s_mul_i32 s41, s44, 28
    s_add_u32 s41, s41, s3
    s_lshl_b32 s48, s41, 10
    s_lshl_b32 s49, s41, 2
    v_lshl_add_u32 v6, v0, 2, s48
    s_lshr_b32 s35, s34, 1
    s_and_b32 s40, s34, 1
    s_mul_i32 s59, s3, 37
    s_lshr_b32 s59, s59, 8
    s_mul_i32 s55, s59, 7
    s_sub_u32 s43, s3, s55
    s_lshl_b32 s55, s44, 2
    s_add_u32 s59, s59, s55
    s_lshl_b32 s45, s34, 1
    v_xor_b32 v18, s45, v17
    s_lshl_b32 s55, s59, 2
    s_add_u32 s55, s55, s34
    s_mul_i32 s56, s55, 14336
    s_lshl_b32 s55, s43, 7
    s_add_u32 s56, s56, s55
    v_lshl_add_u32 v18, v18, 4, v16
    v_add_u32 v18, s56, v18
    s_lshl_b32 s56, s34, 11
    s_add_u32 m0, s56, 124928
    s_waitcnt lgkmcnt(0)
    global_load_dword v2, v6, s[6:7]
    global_load_dword v3, v6, s[8:9]
    global_load_dword v4, v6, s[10:11]
    global_load_dword v5, v6, s[12:13]
    s_load_dword s50, s[14:15], s49
    s_load_dword s51, s[16:17], s49
    s_mov_b32 s42, s59
    s_mov_b32 s52, s45
    s_mov_b32 s36, s32
    s_mov_b32 s37, s33
    global_load_lds_dwordx4 v18, s[4:5]
    v_xor_b32 v18, 16, v18
    v_add_u32 v18, 6144, v18
    global_load_lds_dwordx4 v18, s[4:5] offset:1024
    v_lshrrev_b32 v91, 2, v1
    v_and_b32 v91, 4, v91
    v_xor_b32 v91, v91, v17
    v_lshlrev_b32 v91, 4, v91
    s_lshl_b32 s6, s43, 2
    s_add_u32 s6, s6, s34
    s_mul_i32 s7, s34, 100352
    s_add_u32 s7, s7, s55
    s_add_u32 s7, s7, 3584
    v_mul_u32_u24 v90, 14, v16
    v_add3_u32 v90, v90, v9, s7
    v_add_u32 v84, 6272, v90
    s_lshl_b32 s8, s2, 2
    s_add_u32 s8, s8, s34
    s_sub_u32 s8, s8, 128
    s_mul_i32 s9, s8, 14
    v_min_u32 v250, 13, v1
    v_add_lshl_u32 v250, v250, s9, 7
    s_lshr_b32 s9, s9, 2
    v_min_u32 v251, 3, v1
    v_add_lshl_u32 v251, v251, s9, 7
    v_lshrrev_b32 v94, 5, v1
    v_lshlrev_b32 v94, 9, v94
    v_bfe_u32 v6, v1, 2, 2
    v_lshl_add_u32 v94, v6, 7, v94
    v_bfe_u32 v6, v1, 3, 1
    v_lshl_add_u32 v94, v6, 6, v94
    v_bfe_u32 v6, v1, 4, 1
    v_lshl_add_u32 v94, v6, 5, v94
    v_and_b32 v6, 3, v1
    v_lshl_add_u32 v94, v6, 3, v94
    s_mul_i32 s3, s34, 16896
    s_add_u32 s3, s3, 57344
    s_sub_u32 s59, s3, 45056
    v_and_b32 v6, 31, v1
    v_mul_u32_u24 v6, 528, v6
    v_lshrrev_b32 v7, 5, v1
    v_lshlrev_b32 v16, 4, v7
    v_add3_u32 v21, v6, v16, s3
    v_bfe_u32 v6, v1, 4, 1
    v_and_b32 v16, 3, v1
    v_lshl_add_u32 v6, v6, 2, v16
    v_xor_b32 v17, s52, v6
    v_lshlrev_b32 v17, 4, v17
    v_lshl_add_u32 v17, v6, 10, v17
    v_bfe_u32 v6, v1, 2, 2
    v_lshl_add_u32 v17, v6, 7, v17
    v_lshl_add_u32 v17, v7, 3, v17
    v_add_u32 v86, 124928, v17
    v_xor_b32 v87, 16, v86
    v_lshl_add_u32 v16, v7, 2, v16
    v_mul_u32_u24 v16, 4224, v16
    v_bfe_u32 v6, v1, 2, 3
    v_lshl_add_u32 v16, v6, 4, v16
    s_mul_i32 s3, s6, 67584
    s_lshl_b32 s7, s42, 7
    s_add_u32 s3, s3, s7
    s_add_u32 s3, s3, 17563648
    v_add_u32 v88, s3, v16
    v_add_u32 v89, 33792, v88
    v_lshlrev_b32 v95, 4, v1
    s_mul_i32 s58, s6, 57344
    s_add_u32 s58, s58, 6815744
    s_lshl_b32 s16, s43, 8
    s_add_u32 s16, s16, 32768
    s_lshr_b32 s17, s41, 5
    s_lshl_b32 s17, s17, 8
    s_add_u32 s17, s17, 32768
    s_lshl_b32 s19, s43, 7
    s_add_u32 s19, s19, 24576
    v_lshlrev_b32 v29, 4, v0
    v_add_u32 v80, 4096, v29
    v_add_u32 v81, 12288, v29
    s_mul_i32 s3, s41, 8448
    s_add_u32 s3, s3, 17567744
    v_add_u32 v85, s3, v29
    s_cmp_lg_u32 s34, 0
    s_cselect_b32 s45, 2130706432, 0
    s_cselect_b32 s16, 2130706432, s16
    s_cselect_b32 s17, 2130706432, s17
    s_cselect_b32 s49, 0, 32
    s_mov_b32 s48, 0x3f803f80
    s_mov_b32 m0, s59
    s_waitcnt lgkmcnt(0)
    s_lshl_b32 s52, s50, 16
    s_and_b32 s53, s50, 0xffff0000
    s_cmp_eq_u32 s35, 0
    s_cselect_b32 s50, s52, s53
    s_lshl_b32 s52, s51, 16
    s_and_b32 s53, s51, 0xffff0000
    v_mov_b32 v6, 0x3fb8aa3b
    v_mul_f32 v7, s50, v6
    v_exp_f32 v7, v7
    v_mov_b32 v93, 0
    v_cvt_pk_bf16_f32 v7, v7, v7
    v_lshlrev_b32 v7, 16, v7
    v_mul_f32 v16, 0xbfb8aa3b, v7
    v_mul_f32 v17, 0x3e22f983, v7
    v_add_f32 v18, v7, v7
    s_mov_b64 exec, 0
    s_cmp_eq_u32 s34, 0
    s_cbranch_scc1 K_PGA0
    s_cmp_eq_u32 s34, 1
    s_cbranch_scc1 K_PGA1
    s_cmp_eq_u32 s34, 2
    s_cbranch_scc1 K_PGA2
    s_cmp_eq_u32 s34, 3
    s_cbranch_scc1 K_PGA3
K_WRA:
    s_mov_b64 exec, -1
    s_waitcnt vmcnt(2)
    v_lshlrev_b32 v22, 16, v2
    v_and_b32 v23, 0xffff0000, v2
    v_mul_f32 v22, v22, v6
    v_mul_f32 v23, v23, v6
    v_exp_f32 v22, v22
    v_exp_f32 v23, v23
    v_lshlrev_b32 v24, 16, v3
    v_and_b32 v25, 0xffff0000, v3
    v_cvt_pk_bf16_f32 v2, v22, v23
    v_mul_f32 v24, v24, v17
    v_mul_f32 v25, v25, v17
    v_lshlrev_b32 v22, 16, v2
    v_and_b32 v23, 0xffff0000, v2
    v_mul_f32 v22, v22, v16
    v_mul_f32 v23, v23, v16
    v_lshlrev_b32 v28, 16, v4
    v_and_b32 v29, 0xffff0000, v4
    v_lshlrev_b32 v30, 16, v5
    v_and_b32 v31, 0xffff0000, v5
    v_mul_f32 v28, v28, v18
    v_mul_f32 v29, v29, v18
    v_mul_f32 v30, v30, v18
    v_mul_f32 v31, v31, v18
    v_mul_f32 v68, 0x41000000, v22
    v_mul_f32 v70, 0x41000000, v24
    v_exp_f32 v68, v68
    v_fract_f32 v70, v70
    v_mul_f32 v69, 0x41000000, v23
    v_mul_f32 v71, 0x41000000, v25
    v_exp_f32 v69, v69
    v_fract_f32 v71, v71
    v_cos_f32 v56, v70
    v_sin_f32 v58, v70
    v_cos_f32 v57, v71
    v_sin_f32 v59, v71
    v_pk_mul_f32 v[56:57], v[56:57], v[68:69]
    v_pk_mul_f32 v[58:59], v[58:59], v[68:69]
    v_exp_f32 v68, v22
    v_fract_f32 v70, v24
    v_exp_f32 v69, v23
    v_fract_f32 v71, v25
    v_cos_f32 v52, v70
    v_sin_f32 v54, v70
    v_cos_f32 v53, v71
    v_sin_f32 v55, v71
    v_pk_mul_f32 v[52:53], v[52:53], v[68:69]
    v_pk_mul_f32 v[54:55], v[54:55], v[68:69]
    v_mul_f32 v68, 0x43800000, v22
    v_mul_f32 v70, 0x43800000, v24
    v_exp_f32 v68, v68
    v_fract_f32 v70, v70
    v_mul_f32 v69, 0x43800000, v23
    v_mul_f32 v71, 0x43800000, v25
    v_exp_f32 v69, v69
    v_fract_f32 v71, v71
    v_cos_f32 v60, v70
    v_sin_f32 v62, v70
    v_cos_f32 v61, v71
    v_sin_f32 v63, v71
    v_pk_mul_f32 v[60:61], v[60:61], v[68:69]
    v_pk_mul_f32 v[62:63], v[62:63], v[68:69]

    global_load_dword v255, v250, s[24:25]
    s_nop 0
    v_mov_b32 v208, 0x3f803f80
    v_cvt_pk_bf16_f32 v210, v56, v57
    v_cvt_pk_bf16_f32 v211, v58, v59
    v_pk_mul_f32 v[68:69], v[58:59], v[58:59]
    v_pk_mul_f32 v[70:71], v[58:59], v[56:57]
    v_pk_fma_f32 v[66:67], v[56:57], v[58:59], v[70:71]
    v_pk_fma_f32 v[64:65], v[56:57], v[56:57], v[68:69] neg_lo:[0,0,1] neg_hi:[0,0,1]
    v_cvt_pk_bf16_f32 v212, v64, v65
    v_cvt_pk_bf16_f32 v213, v66, v67
    v_pk_mul_f32 v[68:69], v[66:67], v[58:59]
    v_pk_mul_f32 v[70:71], v[66:67], v[56:57]
    v_pk_fma_f32 v[66:67], v[64:65], v[58:59], v[70:71]
    v_pk_fma_f32 v[64:65], v[64:65], v[56:57], v[68:69] neg_lo:[0,0,1] neg_hi:[0,0,1]
    v_cvt_pk_bf16_f32 v214, v64, v65
    v_cvt_pk_bf16_f32 v215, v66, v67
    ds_write_addtid_b32 v208 offset:45056
    ds_write_addtid_b32 v93 offset:45312
    ds_write_addtid_b32 v210 offset:45584
    ds_write_addtid_b32 v211 offset:45840
    ds_write_addtid_b32 v212 offset:46112
    ds_write_addtid_b32 v213 offset:46368
    ds_write_addtid_b32 v214 offset:46640
    ds_write_addtid_b32 v215 offset:46896
    v_pk_mul_f32 v[68:69], v[66:67], v[58:59]
    v_pk_mul_f32 v[70:71], v[66:67], v[56:57]
    v_pk_fma_f32 v[66:67], v[64:65], v[58:59], v[70:71]
    v_pk_fma_f32 v[64:65], v[64:65], v[56:57], v[68:69] neg_lo:[0,0,1] neg_hi:[0,0,1]
    v_cvt_pk_bf16_f32 v216, v64, v65
    v_cvt_pk_bf16_f32 v217, v66, v67
    v_pk_mul_f32 v[68:69], v[66:67], v[58:59]
    v_pk_mul_f32 v[70:71], v[66:67], v[56:57]
    v_pk_fma_f32 v[66:67], v[64:65], v[58:59], v[70:71]
    v_pk_fma_f32 v[64:65], v[64:65], v[56:57], v[68:69] neg_lo:[0,0,1] neg_hi:[0,0,1]
    v_cvt_pk_bf16_f32 v218, v64, v65
    v_cvt_pk_bf16_f32 v219, v66, v67
    v_pk_mul_f32 v[68:69], v[66:67], v[58:59]
    v_pk_mul_f32 v[70:71], v[66:67], v[56:57]
    v_pk_fma_f32 v[66:67], v[64:65], v[58:59], v[70:71]
    v_pk_fma_f32 v[64:65], v[64:65], v[56:57], v[68:69] neg_lo:[0,0,1] neg_hi:[0,0,1]
    v_cvt_pk_bf16_f32 v220, v64, v65
    v_cvt_pk_bf16_f32 v221, v66, v67
    v_pk_mul_f32 v[68:69], v[66:67], v[58:59]
    v_pk_mul_f32 v[70:71], v[66:67], v[56:57]
    v_pk_fma_f32 v[66:67], v[64:65], v[58:59], v[70:71]
    v_pk_fma_f32 v[64:65], v[64:65], v[56:57], v[68:69] neg_lo:[0,0,1] neg_hi:[0,0,1]
    v_cvt_pk_bf16_f32 v222, v64, v65
    v_cvt_pk_bf16_f32 v223, v66, v67
    ds_write_addtid_b32 v216 offset:47168
    ds_write_addtid_b32 v217 offset:47424
    ds_write_addtid_b32 v218 offset:47696
    ds_write_addtid_b32 v219 offset:47952
    ds_write_addtid_b32 v220 offset:48224
    ds_write_addtid_b32 v221 offset:48480
    ds_write_addtid_b32 v222 offset:48752
    ds_write_addtid_b32 v223 offset:49008
    s_waitcnt vmcnt(1)
    s_barrier
    ds_read_b64_tr_b16 v[224:225], v86 offset:0
    ds_read_b64_tr_b16 v[226:227], v86 offset:512
    ds_read_b64_tr_b16 v[228:229], v87 offset:0
    ds_read_b64_tr_b16 v[230:231], v87 offset:512

    v_pk_mul_f32 v[68:69], v[66:67], v[58:59]
    v_pk_mul_f32 v[70:71], v[66:67], v[56:57]
    v_pk_fma_f32 v[66:67], v[64:65], v[58:59], v[70:71]
    v_pk_fma_f32 v[64:65], v[64:65], v[56:57], v[68:69] neg_lo:[0,0,1] neg_hi:[0,0,1]
    v_cvt_pk_bf16_f32 v208, v64, v65
    v_cvt_pk_bf16_f32 v209, v66, v67
    v_pk_mul_f32 v[68:69], v[66:67], v[58:59]
    v_pk_mul_f32 v[70:71], v[66:67], v[56:57]
    v_pk_fma_f32 v[66:67], v[64:65], v[58:59], v[70:71]
    v_pk_fma_f32 v[64:65], v[64:65], v[56:57], v[68:69] neg_lo:[0,0,1] neg_hi:[0,0,1]
    v_cvt_pk_bf16_f32 v210, v64, v65
    v_cvt_pk_bf16_f32 v211, v66, v67
    s_waitcnt lgkmcnt(0)
    s_nop 0
    global_store_dwordx4 v88, v[224:227], s[32:33] sc1
    v_pk_mul_f32 v[68:69], v[66:67], v[58:59]
    v_pk_mul_f32 v[70:71], v[66:67], v[56:57]
    v_pk_fma_f32 v[66:67], v[64:65], v[58:59], v[70:71]
    v_pk_fma_f32 v[64:65], v[64:65], v[56:57], v[68:69] neg_lo:[0,0,1] neg_hi:[0,0,1]
    v_cvt_pk_bf16_f32 v212, v64, v65
    v_cvt_pk_bf16_f32 v213, v66, v67
    v_pk_mul_f32 v[68:69], v[66:67], v[58:59]
    v_pk_mul_f32 v[70:71], v[66:67], v[56:57]
    v_pk_fma_f32 v[66:67], v[64:65], v[58:59], v[70:71]
    v_pk_fma_f32 v[64:65], v[64:65], v[56:57], v[68:69] neg_lo:[0,0,1] neg_hi:[0,0,1]
    v_cvt_pk_bf16_f32 v214, v64, v65
    v_cvt_pk_bf16_f32 v215, v66, v67
    ds_write_addtid_b32 v208 offset:49280
    ds_write_addtid_b32 v209 offset:49536
    ds_write_addtid_b32 v210 offset:49808
    ds_write_addtid_b32 v211 offset:50064
    ds_write_addtid_b32 v212 offset:50336
    ds_write_addtid_b32 v213 offset:50592
    ds_write_addtid_b32 v214 offset:50864
    ds_write_addtid_b32 v215 offset:51120
    global_store_dwordx4 v89, v[228:231], s[32:33] sc1
    global_load_dword v92, v93, s[30:31] offset:128 sc1
    v_pk_mul_f32 v[68:69], v[66:67], v[58:59]
    v_pk_mul_f32 v[70:71], v[66:67], v[56:57]
    v_pk_fma_f32 v[66:67], v[64:65], v[58:59], v[70:71]
    v_pk_fma_f32 v[64:65], v[64:65], v[56:57], v[68:69] neg_lo:[0,0,1] neg_hi:[0,0,1]
    v_cvt_pk_bf16_f32 v216, v64, v65
    v_cvt_pk_bf16_f32 v217, v66, v67
    v_pk_mul_f32 v[68:69], v[66:67], v[58:59]
    v_pk_mul_f32 v[70:71], v[66:67], v[56:57]
    v_pk_fma_f32 v[66:67], v[64:65], v[58:59], v[70:71]
    v_pk_fma_f32 v[64:65], v[64:65], v[56:57], v[68:69] neg_lo:[0,0,1] neg_hi:[0,0,1]
    v_cvt_pk_bf16_f32 v218, v64, v65
    v_cvt_pk_bf16_f32 v219, v66, v67
    v_pk_mul_f32 v[68:69], v[66:67], v[58:59]
    v_pk_mul_f32 v[70:71], v[66:67], v[56:57]
    v_pk_fma_f32 v[66:67], v[64:65], v[58:59], v[70:71]
    v_pk_fma_f32 v[64:65], v[64:65], v[56:57], v[68:69] neg_lo:[0,0,1] neg_hi:[0,0,1]
    v_cvt_pk_bf16_f32 v220, v64, v65
    v_cvt_pk_bf16_f32 v221, v66, v67
    v_pk_mul_f32 v[68:69], v[66:67], v[58:59]
    v_pk_mul_f32 v[70:71], v[66:67], v[56:57]
    v_pk_fma_f32 v[66:67], v[64:65], v[58:59], v[70:71]
    v_pk_fma_f32 v[64:65], v[64:65], v[56:57], v[68:69] neg_lo:[0,0,1] neg_hi:[0,0,1]
    v_cvt_pk_bf16_f32 v222, v64, v65
    v_cvt_pk_bf16_f32 v223, v66, v67
    ds_write_addtid_b32 v216 offset:51392
    ds_write_addtid_b32 v217 offset:51648
    ds_write_addtid_b32 v218 offset:51920
    ds_write_addtid_b32 v219 offset:52176
    ds_write_addtid_b32 v220 offset:52448
    ds_write_addtid_b32 v221 offset:52704
    ds_write_addtid_b32 v222 offset:52976
    ds_write_addtid_b32 v223 offset:53232
    v_pk_mul_f32 v[68:69], v[66:67], v[58:59]
    v_pk_mul_f32 v[70:71], v[66:67], v[56:57]
    v_pk_fma_f32 v[66:67], v[64:65], v[58:59], v[70:71]
    v_pk_fma_f32 v[64:65], v[64:65], v[56:57], v[68:69] neg_lo:[0,0,1] neg_hi:[0,0,1]
    v_cvt_pk_bf16_f32 v208, v64, v65
    v_cvt_pk_bf16_f32 v209, v66, v67
    v_pk_mul_f32 v[68:69], v[66:67], v[58:59]
    v_pk_mul_f32 v[70:71], v[66:67], v[56:57]
    v_pk_fma_f32 v[66:67], v[64:65], v[58:59], v[70:71]
    v_pk_fma_f32 v[64:65], v[64:65], v[56:57], v[68:69] neg_lo:[0,0,1] neg_hi:[0,0,1]
    v_cvt_pk_bf16_f32 v210, v64, v65
    v_cvt_pk_bf16_f32 v211, v66, v67
    v_pk_mul_f32 v[68:69], v[66:67], v[58:59]
    v_pk_mul_f32 v[70:71], v[66:67], v[56:57]
    v_pk_fma_f32 v[66:67], v[64:65], v[58:59], v[70:71]
    v_pk_fma_f32 v[64:65], v[64:65], v[56:57], v[68:69] neg_lo:[0,0,1] neg_hi:[0,0,1]
    v_cvt_pk_bf16_f32 v212, v64, v65
    v_cvt_pk_bf16_f32 v213, v66, v67
    v_pk_mul_f32 v[68:69], v[66:67], v[58:59]
    v_pk_mul_f32 v[70:71], v[66:67], v[56:57]
    v_pk_fma_f32 v[66:67], v[64:65], v[58:59], v[70:71]
    v_pk_fma_f32 v[64:65], v[64:65], v[56:57], v[68:69] neg_lo:[0,0,1] neg_hi:[0,0,1]
    v_cvt_pk_bf16_f32 v214, v64, v65
    v_cvt_pk_bf16_f32 v215, v66, v67
    ds_write_addtid_b32 v208 offset:53504
    ds_write_addtid_b32 v209 offset:53760
    ds_write_addtid_b32 v210 offset:54032
    ds_write_addtid_b32 v211 offset:54288
    ds_write_addtid_b32 v212 offset:54560
    ds_write_addtid_b32 v213 offset:54816
    ds_write_addtid_b32 v214 offset:55088
    ds_write_addtid_b32 v215 offset:55344
    v_pk_mul_f32 v[68:69], v[66:67], v[58:59]
    v_pk_mul_f32 v[70:71], v[66:67], v[56:57]
    v_pk_fma_f32 v[66:67], v[64:65], v[58:59], v[70:71]
    v_pk_fma_f32 v[64:65], v[64:65], v[56:57], v[68:69] neg_lo:[0,0,1] neg_hi:[0,0,1]
    v_cvt_pk_bf16_f32 v216, v64, v65
    v_cvt_pk_bf16_f32 v217, v66, v67
    v_pk_mul_f32 v[68:69], v[66:67], v[58:59]
    v_pk_mul_f32 v[70:71], v[66:67], v[56:57]
    v_pk_fma_f32 v[66:67], v[64:65], v[58:59], v[70:71]
    v_pk_fma_f32 v[64:65], v[64:65], v[56:57], v[68:69] neg_lo:[0,0,1] neg_hi:[0,0,1]
    v_cvt_pk_bf16_f32 v218, v64, v65
    v_cvt_pk_bf16_f32 v219, v66, v67
    v_pk_mul_f32 v[68:69], v[66:67], v[58:59]
    v_pk_mul_f32 v[70:71], v[66:67], v[56:57]
    v_pk_fma_f32 v[66:67], v[64:65], v[58:59], v[70:71]
    v_pk_fma_f32 v[64:65], v[64:65], v[56:57], v[68:69] neg_lo:[0,0,1] neg_hi:[0,0,1]
    v_cvt_pk_bf16_f32 v220, v64, v65
    v_cvt_pk_bf16_f32 v221, v66, v67
    v_pk_mul_f32 v[68:69], v[66:67], v[58:59]
    v_pk_mul_f32 v[70:71], v[66:67], v[56:57]
    v_pk_fma_f32 v[66:67], v[64:65], v[58:59], v[70:71]
    v_pk_fma_f32 v[64:65], v[64:65], v[56:57], v[68:69] neg_lo:[0,0,1] neg_hi:[0,0,1]
    v_cvt_pk_bf16_f32 v222, v64, v65
    v_cvt_pk_bf16_f32 v223, v66, v67
    ds_write_addtid_b32 v216 offset:55616
    ds_write_addtid_b32 v217 offset:55872
    ds_write_addtid_b32 v218 offset:56144
    ds_write_addtid_b32 v219 offset:56400
    ds_write_addtid_b32 v220 offset:56672
    ds_write_addtid_b32 v221 offset:56928
    ds_write_addtid_b32 v222 offset:57200
    ds_write_addtid_b32 v223 offset:57456
    v_pk_mul_f32 v[68:69], v[66:67], v[58:59]
    v_pk_mul_f32 v[70:71], v[66:67], v[56:57]
    v_pk_fma_f32 v[66:67], v[64:65], v[58:59], v[70:71]
    v_pk_fma_f32 v[64:65], v[64:65], v[56:57], v[68:69] neg_lo:[0,0,1] neg_hi:[0,0,1]
    v_cvt_pk_bf16_f32 v208, v64, v65
    v_cvt_pk_bf16_f32 v209, v66, v67
    v_pk_mul_f32 v[68:69], v[66:67], v[58:59]
    v_pk_mul_f32 v[70:71], v[66:67], v[56:57]
    v_pk_fma_f32 v[66:67], v[64:65], v[58:59], v[70:71]
    v_pk_fma_f32 v[64:65], v[64:65], v[56:57], v[68:69] neg_lo:[0,0,1] neg_hi:[0,0,1]
    v_cvt_pk_bf16_f32 v210, v64, v65
    v_cvt_pk_bf16_f32 v211, v66, v67
    v_pk_mul_f32 v[68:69], v[66:67], v[58:59]
    v_pk_mul_f32 v[70:71], v[66:67], v[56:57]
    v_pk_fma_f32 v[66:67], v[64:65], v[58:59], v[70:71]
    v_pk_fma_f32 v[64:65], v[64:65], v[56:57], v[68:69] neg_lo:[0,0,1] neg_hi:[0,0,1]
    v_cvt_pk_bf16_f32 v212, v64, v65
    v_cvt_pk_bf16_f32 v213, v66, v67
    v_pk_mul_f32 v[68:69], v[66:67], v[58:59]
    v_pk_mul_f32 v[70:71], v[66:67], v[56:57]
    v_pk_fma_f32 v[66:67], v[64:65], v[58:59], v[70:71]
    v_pk_fma_f32 v[64:65], v[64:65], v[56:57], v[68:69] neg_lo:[0,0,1] neg_hi:[0,0,1]
    v_cvt_pk_bf16_f32 v214, v64, v65
    v_cvt_pk_bf16_f32 v215, v66, v67
    ds_write_addtid_b32 v208 offset:57728
    ds_write_addtid_b32 v209 offset:57984
    ds_write_addtid_b32 v210 offset:58256
    ds_write_addtid_b32 v211 offset:58512
    ds_write_addtid_b32 v212 offset:58784
    ds_write_addtid_b32 v213 offset:59040
    ds_write_addtid_b32 v214 offset:59312
    ds_write_addtid_b32 v215 offset:59568
    v_pk_mul_f32 v[68:69], v[66:67], v[58:59]
    v_pk_mul_f32 v[70:71], v[66:67], v[56:57]
    v_pk_fma_f32 v[66:67], v[64:65], v[58:59], v[70:71]
    v_pk_fma_f32 v[64:65], v[64:65], v[56:57], v[68:69] neg_lo:[0,0,1] neg_hi:[0,0,1]
    v_cvt_pk_bf16_f32 v216, v64, v65
    v_cvt_pk_bf16_f32 v217, v66, v67
    v_pk_mul_f32 v[68:69], v[66:67], v[58:59]
    v_pk_mul_f32 v[70:71], v[66:67], v[56:57]
    v_pk_fma_f32 v[66:67], v[64:65], v[58:59], v[70:71]
    v_pk_fma_f32 v[64:65], v[64:65], v[56:57], v[68:69] neg_lo:[0,0,1] neg_hi:[0,0,1]
    v_cvt_pk_bf16_f32 v218, v64, v65
    v_cvt_pk_bf16_f32 v219, v66, v67
    v_pk_mul_f32 v[68:69], v[66:67], v[58:59]
    v_pk_mul_f32 v[70:71], v[66:67], v[56:57]
    v_pk_fma_f32 v[66:67], v[64:65], v[58:59], v[70:71]
    v_pk_fma_f32 v[64:65], v[64:65], v[56:57], v[68:69] neg_lo:[0,0,1] neg_hi:[0,0,1]
    v_cvt_pk_bf16_f32 v220, v64, v65
    v_cvt_pk_bf16_f32 v221, v66, v67
    v_pk_mul_f32 v[68:69], v[66:67], v[58:59]
    v_pk_mul_f32 v[70:71], v[66:67], v[56:57]
    v_pk_fma_f32 v[66:67], v[64:65], v[58:59], v[70:71]
    v_pk_fma_f32 v[64:65], v[64:65], v[56:57], v[68:69] neg_lo:[0,0,1] neg_hi:[0,0,1]
    v_cvt_pk_bf16_f32 v222, v64, v65
    v_cvt_pk_bf16_f32 v223, v66, v67
    ds_write_addtid_b32 v216 offset:59840
K_PGA0:
    s_cbranch_execz K_WRA
    s_nop 0
    ds_write_addtid_b32 v217 offset:60096
    ds_write_addtid_b32 v218 offset:60368
    ds_write_addtid_b32 v219 offset:60624
    ds_write_addtid_b32 v220 offset:60896
    ds_write_addtid_b32 v221 offset:61152
    ds_write_addtid_b32 v222 offset:61424
    ds_write_addtid_b32 v223 offset:61680
    ds_read_b128 v[128:131], v21 offset:0
    ds_read_b128 v[132:135], v21 offset:32
    ds_read_b128 v[136:139], v21 offset:64
    ds_read_b128 v[140:143], v21 offset:96
    v_cvt_pk_bf16_f32 v192, v28, v29
    v_cvt_pk_bf16_f32 v193, -v30, -v31
    v_pk_mul_f32 v[68:69], v[30:31], v[54:55]
    v_pk_mul_f32 v[70:71], v[30:31], v[52:53]
    v_pk_fma_f32 v[50:51], v[28:29], v[54:55], v[70:71]
    v_pk_fma_f32 v[48:49], v[28:29], v[52:53], v[68:69] neg_lo:[0,0,1] neg_hi:[0,0,1]
    v_cvt_pk_bf16_f32 v194, v48, v49
    v_cvt_pk_bf16_f32 v195, -v50, -v51
    ds_read_b128 v[144:147], v21 offset:128
    ds_read_b128 v[148:151], v21 offset:160
    ds_read_b128 v[152:155], v21 offset:192
    ds_read_b128 v[156:159], v21 offset:224
    v_pk_mul_f32 v[68:69], v[50:51], v[54:55]
    v_pk_mul_f32 v[70:71], v[50:51], v[52:53]
    v_pk_fma_f32 v[34:35], v[48:49], v[54:55], v[70:71]
    v_pk_fma_f32 v[32:33], v[48:49], v[52:53], v[68:69] neg_lo:[0,0,1] neg_hi:[0,0,1]
    v_cvt_pk_bf16_f32 v196, v32, v33
    v_cvt_pk_bf16_f32 v197, -v34, -v35
    v_pk_mul_f32 v[68:69], v[34:35], v[54:55]
    v_pk_mul_f32 v[70:71], v[34:35], v[52:53]
    ds_read_b128 v[160:163], v21 offset:256
    ds_read_b128 v[164:167], v21 offset:288
    ds_read_b128 v[168:171], v21 offset:320
    ds_read_b128 v[172:175], v21 offset:352
    v_pk_fma_f32 v[50:51], v[32:33], v[54:55], v[70:71]
    v_pk_fma_f32 v[48:49], v[32:33], v[52:53], v[68:69] neg_lo:[0,0,1] neg_hi:[0,0,1]
    v_cvt_pk_bf16_f32 v198, v48, v49
    v_cvt_pk_bf16_f32 v199, -v50, -v51
    v_pk_mul_f32 v[68:69], v[50:51], v[54:55]
    v_pk_mul_f32 v[70:71], v[50:51], v[52:53]
    v_pk_fma_f32 v[38:39], v[48:49], v[54:55], v[70:71]
    v_pk_fma_f32 v[36:37], v[48:49], v[52:53], v[68:69] neg_lo:[0,0,1] neg_hi:[0,0,1]
    s_waitcnt vmcnt(0)
    v_readfirstlane_b32 s3, v92
    v_mov_b32 v72, 1
    s_cmp_eq_u32 s3, 0
    s_cbranch_scc1 K_ZS
K_ZR:
    s_barrier
    s_mov_b64 exec, 1
    buffer_atomic_add v72, off, s[36:39], s16 sc1
    s_mov_b64 exec, -1

    global_load_dword v73, v93, s[30:31] sc1
    ds_read_b128 v[176:179], v21 offset:384
    ds_read_b128 v[180:183], v21 offset:416
    ds_read_b128 v[184:187], v21 offset:448
    ds_read_b128 v[188:191], v21 offset:480
    v_cvt_pk_bf16_f32 v200, v36, v37
    v_cvt_pk_bf16_f32 v201, -v38, -v39
    v_pk_mul_f32 v[68:69], v[38:39], v[54:55]
    v_pk_mul_f32 v[70:71], v[38:39], v[52:53]
    v_pk_fma_f32 v[50:51], v[36:37], v[54:55], v[70:71]
    global_load_dword v255, v251, s[20:21]
    global_load_dword v255, v251, s[22:23]
    global_load_dword v255, v250, s[26:27]
    v_pk_fma_f32 v[48:49], v[36:37], v[52:53], v[68:69] neg_lo:[0,0,1] neg_hi:[0,0,1]
    v_cvt_pk_bf16_f32 v202, v48, v49
    v_cvt_pk_bf16_f32 v203, -v50, -v51
    ds_write_addtid_b32 v192 offset:45056
    ds_write_addtid_b32 v193 offset:45312
    ds_write_addtid_b32 v194 offset:45584
    ds_write_addtid_b32 v195 offset:45840
    ds_write_addtid_b32 v196 offset:46112
    ds_write_addtid_b32 v197 offset:46368
    ds_write_addtid_b32 v198 offset:46640
    ds_write_addtid_b32 v199 offset:46896
    ds_write_addtid_b32 v200 offset:47168
    ds_write_addtid_b32 v201 offset:47424
    ds_write_addtid_b32 v200 offset:49280
    ds_write_addtid_b32 v201 offset:49536
    ds_write_addtid_b32 v202 offset:47696
    ds_write_addtid_b32 v203 offset:47952
    v_pk_mul_f32 v[68:69], v[50:51], v[54:55]
    v_pk_mul_f32 v[70:71], v[50:51], v[52:53]
    v_pk_fma_f32 v[42:43], v[48:49], v[54:55], v[70:71]
    v_pk_fma_f32 v[40:41], v[48:49], v[52:53], v[68:69] neg_lo:[0,0,1] neg_hi:[0,0,1]
    v_cvt_pk_bf16_f32 v208, v40, v41
    v_cvt_pk_bf16_f32 v209, -v42, -v43
    v_pk_mul_f32 v[68:69], v[42:43], v[54:55]
    v_pk_mul_f32 v[70:71], v[42:43], v[52:53]
    v_pk_fma_f32 v[50:51], v[40:41], v[54:55], v[70:71]
    v_pk_fma_f32 v[48:49], v[40:41], v[52:53], v[68:69] neg_lo:[0,0,1] neg_hi:[0,0,1]
    v_cvt_pk_bf16_f32 v210, v48, v49
    v_cvt_pk_bf16_f32 v211, -v50, -v51
    ds_write_addtid_b32 v208 offset:48224
    ds_write_addtid_b32 v209 offset:48480
    ds_write_addtid_b32 v210 offset:48752
    ds_write_addtid_b32 v211 offset:49008
    v_pk_mul_f32 v[68:69], v[50:51], v[54:55]
    v_pk_mul_f32 v[70:71], v[50:51], v[52:53]
    v_pk_fma_f32 v[46:47], v[48:49], v[54:55], v[70:71]
    v_pk_fma_f32 v[44:45], v[48:49], v[52:53], v[68:69] neg_lo:[0,0,1] neg_hi:[0,0,1]
    v_cvt_pk_bf16_f32 v212, v44, v45
    v_cvt_pk_bf16_f32 v213, -v46, -v47
    v_pk_mul_f32 v[68:69], v[30:31], v[62:63]
    v_pk_mul_f32 v[70:71], v[30:31], v[60:61]
    v_pk_fma_f32 v[30:31], v[28:29], v[62:63], v[70:71]
    v_pk_fma_f32 v[28:29], v[28:29], v[60:61], v[68:69] neg_lo:[0,0,1] neg_hi:[0,0,1]
    v_cvt_pk_bf16_f32 v214, v28, v29
    v_cvt_pk_bf16_f32 v215, -v30, -v31
    v_pk_mul_f32 v[68:69], v[34:35], v[62:63]
    v_pk_mul_f32 v[70:71], v[34:35], v[60:61]
    v_pk_fma_f32 v[34:35], v[32:33], v[62:63], v[70:71]
    v_pk_fma_f32 v[32:33], v[32:33], v[60:61], v[68:69] neg_lo:[0,0,1] neg_hi:[0,0,1]
    v_cvt_pk_bf16_f32 v216, v32, v33
    v_cvt_pk_bf16_f32 v217, -v34, -v35
    v_pk_mul_f32 v[68:69], v[38:39], v[62:63]
    v_pk_mul_f32 v[70:71], v[38:39], v[60:61]
    v_pk_fma_f32 v[38:39], v[36:37], v[62:63], v[70:71]
    v_pk_fma_f32 v[36:37], v[36:37], v[60:61], v[68:69] neg_lo:[0,0,1] neg_hi:[0,0,1]
    v_cvt_pk_bf16_f32 v218, v36, v37
    v_cvt_pk_bf16_f32 v219, -v38, -v39
    ds_write_addtid_b32 v212 offset:51392
    ds_write_addtid_b32 v213 offset:51648
    ds_write_addtid_b32 v214 offset:53504
    ds_write_addtid_b32 v215 offset:53760
    ds_write_addtid_b32 v216 offset:54032
    ds_write_addtid_b32 v217 offset:54288
    ds_write_addtid_b32 v218 offset:54560
    ds_write_addtid_b32 v219 offset:54816
    ds_write_addtid_b32 v218 offset:55616
    ds_write_addtid_b32 v219 offset:55872
    v_pk_mul_f32 v[68:69], v[42:43], v[62:63]
    v_pk_mul_f32 v[70:71], v[42:43], v[60:61]
    v_pk_fma_f32 v[42:43], v[40:41], v[62:63], v[70:71]
    v_pk_fma_f32 v[40:41], v[40:41], v[60:61], v[68:69] neg_lo:[0,0,1] neg_hi:[0,0,1]
    v_cvt_pk_bf16_f32 v220, v40, v41
    v_cvt_pk_bf16_f32 v221, -v42, -v43
    v_pk_mul_f32 v[68:69], v[46:47], v[62:63]
    v_pk_mul_f32 v[70:71], v[46:47], v[60:61]
    v_pk_fma_f32 v[46:47], v[44:45], v[62:63], v[70:71]
    v_pk_fma_f32 v[44:45], v[44:45], v[60:61], v[68:69] neg_lo:[0,0,1] neg_hi:[0,0,1]
    v_cvt_pk_bf16_f32 v222, v44, v45
    v_cvt_pk_bf16_f32 v223, -v46, -v47
    v_pk_mul_f32 v[68:69], v[30:31], v[62:63]
    v_pk_mul_f32 v[70:71], v[30:31], v[60:61]
    v_pk_fma_f32 v[30:31], v[28:29], v[62:63], v[70:71]
    v_pk_fma_f32 v[28:29], v[28:29], v[60:61], v[68:69] neg_lo:[0,0,1] neg_hi:[0,0,1]
    v_cvt_pk_bf16_f32 v208, v28, v29
    v_cvt_pk_bf16_f32 v209, -v30, -v31
    v_pk_mul_f32 v[68:69], v[38:39], v[62:63]
    v_pk_mul_f32 v[70:71], v[38:39], v[60:61]
    v_pk_fma_f32 v[38:39], v[36:37], v[62:63], v[70:71]
    v_pk_fma_f32 v[36:37], v[36:37], v[60:61], v[68:69] neg_lo:[0,0,1] neg_hi:[0,0,1]
    v_cvt_pk_bf16_f32 v210, v36, v37
    v_cvt_pk_bf16_f32 v211, -v38, -v39
    ds_write_addtid_b32 v220 offset:56144
    ds_write_addtid_b32 v221 offset:56400
    ds_write_addtid_b32 v222 offset:56672
    ds_write_addtid_b32 v223 offset:56928
    ds_write_addtid_b32 v208 offset:49808
    ds_write_addtid_b32 v209 offset:50064
    ds_write_addtid_b32 v210 offset:50336
    ds_write_addtid_b32 v211 offset:50592
    v_pk_mul_f32 v[68:69], v[46:47], v[62:63]
    v_pk_mul_f32 v[70:71], v[46:47], v[60:61]
    v_pk_fma_f32 v[46:47], v[44:45], v[62:63], v[70:71]
    v_pk_fma_f32 v[44:45], v[44:45], v[60:61], v[68:69] neg_lo:[0,0,1] neg_hi:[0,0,1]
    v_cvt_pk_bf16_f32 v212, v44, v45
    v_cvt_pk_bf16_f32 v213, -v46, -v47
    v_pk_mul_f32 v[68:69], v[30:31], v[62:63]
    v_pk_mul_f32 v[70:71], v[30:31], v[60:61]
    v_pk_fma_f32 v[30:31], v[28:29], v[62:63], v[70:71]
    v_pk_fma_f32 v[28:29], v[28:29], v[60:61], v[68:69] neg_lo:[0,0,1] neg_hi:[0,0,1]
    v_cvt_pk_bf16_f32 v214, v28, v29
    v_cvt_pk_bf16_f32 v215, -v30, -v31
    v_pk_mul_f32 v[68:69], v[38:39], v[62:63]
    v_pk_mul_f32 v[70:71], v[38:39], v[60:61]
    v_pk_fma_f32 v[38:39], v[36:37], v[62:63], v[70:71]
    v_pk_fma_f32 v[36:37], v[36:37], v[60:61], v[68:69] neg_lo:[0,0,1] neg_hi:[0,0,1]
    v_cvt_pk_bf16_f32 v216, v36, v37
    v_cvt_pk_bf16_f32 v217, -v38, -v39
    v_pk_mul_f32 v[68:69], v[46:47], v[62:63]
    v_pk_mul_f32 v[70:71], v[46:47], v[60:61]
    v_pk_fma_f32 v[46:47], v[44:45], v[62:63], v[70:71]
    v_pk_fma_f32 v[44:45], v[44:45], v[60:61], v[68:69] neg_lo:[0,0,1] neg_hi:[0,0,1]
    v_cvt_pk_bf16_f32 v218, v44, v45
    v_cvt_pk_bf16_f32 v219, -v46, -v47
    ds_write_addtid_b32 v212 offset:50864
    ds_write_addtid_b32 v213 offset:51120
    ds_write_addtid_b32 v214 offset:51920
    ds_write_addtid_b32 v215 offset:52176
    ds_write_addtid_b32 v216 offset:52448
    ds_write_addtid_b32 v217 offset:52704
    ds_write_addtid_b32 v218 offset:52976
    ds_write_addtid_b32 v219 offset:53232
    v_pk_mul_f32 v[68:69], v[30:31], v[62:63]
    v_pk_mul_f32 v[70:71], v[30:31], v[60:61]
    v_pk_fma_f32 v[30:31], v[28:29], v[62:63], v[70:71]
    v_pk_fma_f32 v[28:29], v[28:29], v[60:61], v[68:69] neg_lo:[0,0,1] neg_hi:[0,0,1]
    v_cvt_pk_bf16_f32 v220, v28, v29
    v_cvt_pk_bf16_f32 v221, -v30, -v31
    v_pk_mul_f32 v[68:69], v[46:47], v[62:63]
    v_pk_mul_f32 v[70:71], v[46:47], v[60:61]
    v_pk_fma_f32 v[46:47], v[44:45], v[62:63], v[70:71]
    v_pk_fma_f32 v[44:45], v[44:45], v[60:61], v[68:69] neg_lo:[0,0,1] neg_hi:[0,0,1]
    v_cvt_pk_bf16_f32 v222, v44, v45
    v_cvt_pk_bf16_f32 v223, -v46, -v47
    v_pk_mul_f32 v[68:69], v[30:31], v[62:63]
    v_pk_mul_f32 v[70:71], v[30:31], v[60:61]
    v_pk_fma_f32 v[30:31], v[28:29], v[62:63], v[70:71]
    v_pk_fma_f32 v[28:29], v[28:29], v[60:61], v[68:69] neg_lo:[0,0,1] neg_hi:[0,0,1]
    v_cvt_pk_bf16_f32 v208, v28, v29
    v_cvt_pk_bf16_f32 v209, -v30, -v31
    v_pk_mul_f32 v[68:69], v[46:47], v[62:63]
    v_pk_mul_f32 v[70:71], v[46:47], v[60:61]
    v_pk_fma_f32 v[46:47], v[44:45], v[62:63], v[70:71]
    v_pk_fma_f32 v[44:45], v[44:45], v[60:61], v[68:69] neg_lo:[0,0,1] neg_hi:[0,0,1]
    v_cvt_pk_bf16_f32 v210, v44, v45
    v_cvt_pk_bf16_f32 v211, -v46, -v47
    ds_write_addtid_b32 v220 offset:55088
    ds_write_addtid_b32 v221 offset:55344
    ds_write_addtid_b32 v222 offset:57728
    ds_write_addtid_b32 v223 offset:57984
    ds_write_addtid_b32 v208 offset:58256
    ds_write_addtid_b32 v209 offset:58512
    ds_write_addtid_b32 v210 offset:58784
    ds_write_addtid_b32 v211 offset:59040
    v_pk_mul_f32 v[68:69], v[30:31], v[62:63]
    v_pk_mul_f32 v[70:71], v[30:31], v[60:61]
    v_pk_fma_f32 v[30:31], v[28:29], v[62:63], v[70:71]
    v_pk_fma_f32 v[28:29], v[28:29], v[60:61], v[68:69] neg_lo:[0,0,1] neg_hi:[0,0,1]
    v_cvt_pk_bf16_f32 v212, v28, v29
    v_cvt_pk_bf16_f32 v213, -v30, -v31
    v_mov_b32 v92, 0
    s_mov_b64 exec, 1
    buffer_atomic_add v92, off, s[36:39], s17 sc0 sc1
    s_mov_b64 exec, -1
    s_nop 0
    v_pk_mul_f32 v[68:69], v[46:47], v[62:63]
    v_pk_mul_f32 v[70:71], v[46:47], v[60:61]
    v_pk_fma_f32 v[46:47], v[44:45], v[62:63], v[70:71]
    v_pk_fma_f32 v[44:45], v[44:45], v[60:61], v[68:69] neg_lo:[0,0,1] neg_hi:[0,0,1]
    v_cvt_pk_bf16_f32 v214, v44, v45
    v_cvt_pk_bf16_f32 v215, -v46, -v47
    v_pk_mul_f32 v[68:69], v[30:31], v[62:63]
    v_pk_mul_f32 v[70:71], v[30:31], v[60:61]
    v_pk_fma_f32 v[30:31], v[28:29], v[62:63], v[70:71]
    v_pk_fma_f32 v[28:29], v[28:29], v[60:61], v[68:69] neg_lo:[0,0,1] neg_hi:[0,0,1]
    v_cvt_pk_bf16_f32 v216, v28, v29
    v_cvt_pk_bf16_f32 v217, -v30, -v31
    v_pk_mul_f32 v[68:69], v[46:47], v[62:63]
    v_pk_mul_f32 v[70:71], v[46:47], v[60:61]
    v_pk_fma_f32 v[46:47], v[44:45], v[62:63], v[70:71]
    v_pk_fma_f32 v[44:45], v[44:45], v[60:61], v[68:69] neg_lo:[0,0,1] neg_hi:[0,0,1]
    v_cvt_pk_bf16_f32 v218, v44, v45
    v_cvt_pk_bf16_f32 v219, -v46, -v47
    ds_write_addtid_b32 v212 offset:57200
    ds_write_addtid_b32 v213 offset:57456
    ds_write_addtid_b32 v214 offset:59840
    ds_write_addtid_b32 v215 offset:60096
    ds_write_addtid_b32 v216 offset:60368
    ds_write_addtid_b32 v217 offset:60624
    ds_write_addtid_b32 v218 offset:60896
    ds_write_addtid_b32 v219 offset:61152
    ds_read_b128 v[192:195], v21 offset:0
    ds_read_b128 v[196:199], v21 offset:32
    ds_read_b128 v[200:203], v21 offset:64
    ds_read_b128 v[204:207], v21 offset:96
    ds_read_b128 v[208:211], v21 offset:128
    ds_read_b128 v[212:215], v21 offset:160
    s_waitcnt vmcnt(4)
    v_cmp_gt_u32 vcc, 32, v73
    s_cbranch_vccnz K_Z2s
K_Z2r:
    s_lshl_b32 s3, s34, 11
    s_add_u32 s4, s3, 124928
    v_add_u32 v82, s4, v95
    s_xor_b32 s3, s3, 2048
    s_add_u32 s4, s3, 124928
    v_add_u32 v83, s4, v95
    s_mul_i32 s5, s35, 8448
    s_add_u32 s5, s5, 69696
    v_and_b32 v16, 31, v1
    s_waitcnt lgkmcnt(4)
    v_mfma_f32_32x32x16_bf16 v[96:111], v[192:195], v[128:131], 0
    ds_read_b128 v[216:219], v21 offset:192
    global_load_dwordx4 v[64:67], v80, s[32:33] offset:-4096 sc1
    v_lshl_add_u32 v16, v16, 5, s5
    v_lshrrev_b32 v17, 5, v1
    v_mfma_f32_32x32x16_bf16 v[96:111], v[196:199], v[132:135], v[96:111]
    ds_read_b128 v[220:223], v21 offset:224
    global_load_dwordx4 v[68:71], v80, s[32:33] offset:0 sc1
    v_lshlrev_b32 v29, 4, v0
    v_and_b32 v6, 15, v1
    s_waitcnt lgkmcnt(4)
    v_mfma_f32_32x32x16_bf16 v[96:111], v[200:203], v[136:139], v[96:111]
    ds_read_b128 v[192:195], v21 offset:256
    global_load_dwordx4 v[72:75], v81, s[32:33] offset:-4096 sc1
    v_lshrrev_b32 v7, 4, v1
    s_lshl_b32 s4, s40, 9
    v_mfma_f32_32x32x16_bf16 v[96:111], v[204:207], v[140:143], v[96:111]
    ds_read_b128 v[196:199], v21 offset:288
    global_load_dwordx4 v[76:79], v81, s[32:33] offset:0 sc1
    s_add_u32 s4, s4, s5
    s_add_u32 s4, s4, 36
    s_waitcnt lgkmcnt(4)
    v_mfma_f32_32x32x16_bf16 v[96:111], v[208:211], v[144:147], v[96:111]
    ds_read_b128 v[200:203], v21 offset:320
    global_load_dwordx4 a[144:147], v90, s[20:21] offset:-3584
    v_lshlrev_b32 v2, 5, v7
    v_mfma_f32_32x32x16_bf16 v[96:111], v[212:215], v[148:151], v[96:111]
    ds_read_b128 v[204:207], v21 offset:352
    v_lshl_add_u32 v242, v6, 2, s4
    v_sub_u32 v242, v242, v2
    v_add_u32 v243, 1024, v242
    v_add_u32 v244, 2048, v242
    s_waitcnt lgkmcnt(4)
    v_mfma_f32_32x32x16_bf16 v[96:111], v[216:219], v[152:155], v[96:111]
    ds_read_b128 v[208:211], v21 offset:384
    global_load_dwordx4 a[148:151], v90, s[20:21] offset:-2688
    v_add_u32 v245, 3072, v242
    v_mfma_f32_32x32x16_bf16 v[96:111], v[220:223], v[156:159], v[96:111]
    ds_read_b128 v[212:215], v21 offset:416
    v_add_u32 v246, 4096, v242
    v_add_u32 v247, 5120, v242
    v_add_u32 v248, 6144, v242
    v_add_u32 v249, 7168, v242
    s_waitcnt lgkmcnt(4)
    v_mfma_f32_32x32x16_bf16 v[96:111], v[192:195], v[160:163], v[96:111]
    ds_read_b128 v[216:219], v21 offset:448
    global_load_dwordx4 a[152:155], v90, s[20:21] offset:-1792
    s_mul_i32 s3, s35, 4608
    v_mfma_f32_32x32x16_bf16 v[96:111], v[196:199], v[164:167], v[96:111]
    ds_read_b128 v[220:223], v21 offset:480
    s_add_u32 s6, s3, 57344
    v_min_u32 v87, 29, v1
    v_lshl_add_u32 v87, v87, 4, s6
    s_lshl_b32 s4, s40, 8
    s_waitcnt lgkmcnt(4)
    v_mfma_f32_32x32x16_bf16 v[96:111], v[200:203], v[168:171], v[96:111]
    global_load_dwordx4 a[156:159], v90, s[20:21] offset:-896
    s_sub_u32 s3, s3, s4
    s_add_u32 s3, s3, 57600
    v_mfma_f32_32x32x16_bf16 v[96:111], v[204:207], v[172:175], v[96:111]
    v_lshlrev_b32 v2, 5, v6
    v_lshlrev_b32 v3, 4, v7
    v_add3_u32 v22, v2, v3, s3
    v_add_u32 v23, 57824, v29
    v_lshlrev_b32 v24, 5, v0
    s_waitcnt lgkmcnt(2)
    v_mfma_f32_32x32x16_bf16 v[96:111], v[208:211], v[176:179], v[96:111]
    global_load_dwordx4 a[160:163], v90, s[20:21] offset:0
    v_add_u32 v24, 86528, v24
    v_and_b32 v18, 1, v1
    v_mfma_f32_32x32x16_bf16 v[96:111], v[212:215], v[180:183], v[96:111]
    s_lshl_b32 s3, s35, 13
    s_add_u32 s4, s3, 86528
    v_lshlrev_b32 v2, 6, v6
    v_add3_u32 v25, v2, v3, s4
    s_lshl_b32 s3, s34, 12
    s_waitcnt lgkmcnt(0)
    v_mfma_f32_32x32x16_bf16 v[96:111], v[216:219], v[184:187], v[96:111]
    global_load_dwordx4 a[164:167], v90, s[20:21] offset:896
    s_add_u32 s4, s3, 65536
    v_add_u32 v26, s4, v95
    v_mfma_f32_32x32x16_bf16 v[96:111], v[220:223], v[188:191], v[96:111]
    v_xor_b32 v27, 4096, v26
    s_lshl_b32 s3, s40, 3
    s_sub_u32 s3, 12, s3
    v_and_b32 v11, 1, v7
    v_lshrrev_b32 v10, 2, v6
    v_mad_u32_u24 v10, v11, s3, v10
    v_mul_u32_u24 v10, 57344, v10
    v_and_b32 v11, 3, v6
    v_lshlrev_b32 v11, 5, v11
    v_lshrrev_b32 v12, 1, v7
    v_lshl_add_u32 v11, v12, 4, v11
    s_lshl_b32 s3, s41, 1
    s_add_u32 s3, s3, s35
    s_lshl_b32 s3, s3, 7
    s_mul_i32 s4, s40, 229376
    s_add_u32 s3, s3, s4
    s_add_u32 s3, s3, 1048576
    v_add3_u32 v28, v10, v11, s3
    v_add_u32 v31, 917504, v28
    v_cmp_eq_u32 s[6:7], 1, v18
    s_cmp_eq_u32 s40, 0
    s_cbranch_scc0 K_XH1
    ds_write_b128 v82, v[104:107]
    ds_write_b128 v82, v[108:111] offset:1024
    v_lshl_add_u32 v18, v17, 4, v16
    v_lshl_add_u32 v19, v17, 10, v16
    s_waitcnt vmcnt(10)
    v_cmp_gt_u32 vcc, s49, v92
    s_nop 0
    s_and_b32 s55, vcc_lo, 1
    s_cbranch_scc1 K_PS
K_PR:
    s_waitcnt lgkmcnt(0)
    s_barrier
    ds_read_b128 v[112:115], v83
    ds_read_b128 v[116:119], v83 offset:1024
    global_load_dwordx4 v[224:227], v85, s[32:33] offset:-4096 sc1
    global_load_dwordx4 v[228:231], v85, s[32:33] offset:128 sc1
    s_waitcnt vmcnt(8)
    v_min3_u32 v20, v64, v65, v66
    v_min3_u32 v20, v20, v67, v68
    v_min3_u32 v20, v20, v69, v70
    v_min3_u32 v20, v20, v71, v72
    v_min3_u32 v20, v20, v73, v74
    v_min3_u32 v20, v20, v75, v76
    v_min3_u32 v20, v20, v77, v78
    v_min_u32 v20, v20, v79
    v_cmp_eq_u32 vcc, 0, v20
    s_cbranch_vccnz K_SS0
K_SR0:
    s_waitcnt lgkmcnt(0)
    v_pk_add_f32 v[112:113], v[112:113], v[96:97]
    v_pk_add_f32 v[114:115], v[114:115], v[98:99]
    v_pk_add_f32 v[116:117], v[116:117], v[100:101]
    v_pk_add_f32 v[118:119], v[118:119], v[102:103]
    v_cvt_pk_bf16_f32 v120, v113, v112
    v_cvt_pk_bf16_f32 v121, v114, v113
    v_cvt_pk_bf16_f32 v122, v115, v114
    v_cvt_pk_bf16_f32 v123, v116, v115
    v_cvt_pk_bf16_f32 v124, v117, v117
    v_cvt_pk_bf16_f32 v125, v117, v117
    v_cvt_pk_bf16_f32 v126, v118, v117
    v_cvt_pk_bf16_f32 v127, v118, v118
    v_cvt_pk_bf16_f32 v128, v118, v118
    v_cvt_pk_bf16_f32 v129, v119, v118
    v_cvt_pk_bf16_f32 v130, v119, v119
    v_cvt_pk_bf16_f32 v131, v119, v119
    ds_write_b128 v18, v[120:123]
    ds_write_b128 v19, v[124:127] offset:2048
    ds_write_b128 v19, v[128:131] offset:2064
    v_mov_b32 v132, 0
    v_mov_b32 v133, 0
    v_mov_b32 v134, 0
    v_mov_b32 v135, 0
    v_mov_b32 v136, 0
    v_cvt_pk_bf16_f32 v137, v112, 0
    v_cmp_eq_u32 vcc, 0, v1
    v_min_u32 v13, 3, v1
    v_lshlrev_b32 v13, 4, v13
    v_cndmask_b32 v137, 0, v137, vcc
    v_sub_u32 v13, s5, v13
    v_subrev_u32 v13, 16, v13
    ds_write_b128 v13, v[134:137]
    ds_write_b128 v87, v[132:135]
    s_branch K_XD
K_XH1:
    s_nop 8
    ds_write_b128 v82, v[96:99]
    ds_write_b128 v82, v[100:103] offset:1024
    v_lshl_add_u32 v18, v17, 4, v16
    v_lshl_add_u32 v19, v17, 11, v16
    s_waitcnt lgkmcnt(0)
    s_barrier
    ds_read_b128 v[112:115], v83
    ds_read_b128 v[116:119], v83 offset:1024
    global_load_dwordx4 v[224:227], v85, s[32:33] offset:-4096 sc1
    global_load_dwordx4 v[228:231], v85, s[32:33] offset:128 sc1
    s_waitcnt vmcnt(8)
    v_min3_u32 v20, v64, v65, v66
    v_min3_u32 v20, v20, v67, v68
    v_min3_u32 v20, v20, v69, v70
    v_min3_u32 v20, v20, v71, v72
    v_min3_u32 v20, v20, v73, v74
    v_min3_u32 v20, v20, v75, v76
    v_min3_u32 v20, v20, v77, v78
    v_min_u32 v20, v20, v79
    v_cmp_eq_u32 vcc, 0, v20
    s_cbranch_vccnz K_SS1
K_SR1:
    s_waitcnt lgkmcnt(0)
    v_pk_add_f32 v[112:113], v[112:113], v[104:105]
    v_pk_add_f32 v[114:115], v[114:115], v[106:107]
    v_pk_add_f32 v[116:117], v[116:117], v[108:109]
    v_pk_add_f32 v[118:119], v[118:119], v[110:111]
    v_cvt_pk_bf16_f32 v120, v112, v112
    v_cvt_pk_bf16_f32 v121, v113, v112
    v_cvt_pk_bf16_f32 v122, v114, v113
    v_cvt_pk_bf16_f32 v123, v114, v114
    v_cndmask_b32 v119, v115, v116, s[6:7]
    v_cvt_pk_bf16_f32 v124, v115, v115
    v_cvt_pk_bf16_f32 v125, v115, v115
    v_cvt_pk_bf16_f32 v126, v115, v115
    v_cvt_pk_bf16_f32 v127, v119, v115
    v_cvt_pk_bf16_f32 v128, v116, v119
    v_cvt_pk_bf16_f32 v129, v116, v116
    v_cvt_pk_bf16_f32 v130, v116, v116
    v_cvt_pk_bf16_f32 v131, v116, v116
    ds_write_b128 v18, v[120:123] offset:1024
    ds_write_b128 v19, v[124:127] offset:4096
    ds_write_b128 v19, v[128:131] offset:4112
    v_cndmask_b32 v119, v117, v118, s[6:7]
    v_cvt_pk_bf16_f32 v132, v117, v117
    v_cvt_pk_bf16_f32 v133, v117, v117
    v_cvt_pk_bf16_f32 v134, v117, v117
    v_cvt_pk_bf16_f32 v135, v119, v117
    v_cvt_pk_bf16_f32 v136, v118, v119
    v_cvt_pk_bf16_f32 v137, v118, v118
    v_cvt_pk_bf16_f32 v138, v118, v118
    v_cvt_pk_bf16_f32 v139, v118, v118
    ds_write_b128 v19, v[132:135] offset:5120
    ds_write_b128 v19, v[136:139] offset:5136
K_XD:
    s_waitcnt vmcnt(1)
    v_lshlrev_b32 v32, 16, v224
    v_and_b32 v33, 0xffff0000, v224
    v_lshlrev_b32 v34, 16, v225
    v_and_b32 v35, 0xffff0000, v225
    v_lshlrev_b32 v36, 16, v226
    v_and_b32 v37, 0xffff0000, v226
    v_lshlrev_b32_e64 v38, 16, v227
    v_and_b32 v39, 0xffff0000, v227
    v_pk_fma_f32 v[48:49], v[32:33], v[64:65], v[66:67]
    v_pk_fma_f32 v[50:51], v[34:35], v[68:69], v[70:71]
    v_pk_fma_f32 v[52:53], v[36:37], v[72:73], v[74:75]
    v_pk_fma_f32 v[54:55], v[38:39], v[76:77], v[78:79]
    v_cvt_pk_bf16_f32 v192, v48, v49
    v_cvt_pk_bf16_f32 v193, v50, v51
    v_cvt_pk_bf16_f32 v194, v52, v53
    v_cvt_pk_bf16_f32 v195, v54, v55
    ds_write_b128 v23, v[192:195] offset:0
    s_waitcnt vmcnt(0)
    v_lshlrev_b32 v40, 16, v228
    v_and_b32 v41, 0xffff0000, v228
    v_lshlrev_b32 v42, 16, v229
    v_and_b32 v43, 0xffff0000, v229
    v_lshlrev_b32 v44, 16, v230
    v_and_b32 v45, 0xffff0000, v230
    v_lshlrev_b32_e64 v46, 16, v231
    v_and_b32 v47, 0xffff0000, v231
    v_pk_fma_f32 v[56:57], v[40:41], v[64:65], v[66:67]
    v_pk_fma_f32 v[58:59], v[42:43], v[68:69], v[70:71]
    v_pk_fma_f32 v[60:61], v[44:45], v[72:73], v[74:75]
    v_pk_fma_f32 v[62:63], v[46:47], v[76:77], v[78:79]
    v_cvt_pk_bf16_f32 v196, v56, v57
    v_cvt_pk_bf16_f32 v197, v58, v59
    v_cvt_pk_bf16_f32 v198, v60, v61
    v_cvt_pk_bf16_f32 v199, v62, v63
    ds_write_b128 v23, v[196:199] offset:4608
    global_load_dwordx4 a[168:171], v90, s[20:21] offset:1792
    global_load_dwordx4 a[172:175], v84, s[20:21] offset:-3584
    global_load_dwordx4 a[176:179], v84, s[20:21] offset:-2688
    global_load_dwordx4 a[180:183], v84, s[20:21] offset:-1792
    s_waitcnt lgkmcnt(0)
    s_barrier
    ds_read_b128 v[192:195], v22 offset:192
    ds_read2_b32 v[128:129], v242 offset0:6 offset1:4
    ds_read2_b32 v[130:131], v242 offset0:2 offset1:0
    ds_read_b128 v[196:199], v22 offset:704
    ds_read2_b32 v[132:133], v243 offset0:6 offset1:4
    ds_read2_b32 v[134:135], v243 offset0:2 offset1:0
    ds_read_b128 v[200:203], v22 offset:1216
    ds_read2_b32 v[136:137], v244 offset0:6 offset1:4
    ds_read2_b32 v[138:139], v244 offset0:2 offset1:0
    ds_read_b128 v[204:207], v22 offset:1728
    ds_read2_b32 v[140:141], v245 offset0:6 offset1:4
    ds_read2_b32 v[142:143], v245 offset0:2 offset1:0
    s_waitcnt lgkmcnt(9)
    v_mfma_f32_16x16x32_bf16 v[64:67], v[128:131], v[192:195], 0
    ds_read_b128 v[208:211], v22 offset:2240
    ds_read2_b32 v[144:145], v246 offset0:6 offset1:4
    s_waitcnt lgkmcnt(8)
    v_mfma_f32_16x16x32_bf16 v[68:71], v[128:131], v[196:199], 0
K_PGA1:
    s_cbranch_execz K_WRA
    s_nop 0
    ds_read2_b32 v[146:147], v246 offset0:2 offset1:0
    v_mfma_f32_16x16x32_bf16 v[68:71], v[132:135], v[192:195], v[68:71]
    ds_read_b128 v[212:215], v22 offset:2752
    v_mfma_f32_16x16x32_bf16 v[72:75], v[132:135], v[196:199], 0
    global_load_dwordx4 a[184:187], v84, s[20:21] offset:-896
    ds_read2_b32 v[148:149], v247 offset0:6 offset1:4
    s_waitcnt lgkmcnt(8)
    v_mfma_f32_16x16x32_bf16 v[72:75], v[128:131], v[200:203], v[72:75]
    ds_read2_b32 v[150:151], v247 offset0:2 offset1:0
    v_mfma_f32_16x16x32_bf16 v[76:79], v[132:135], v[200:203], 0
    ds_read_b128 v[216:219], v22 offset:3264
    v_mfma_f32_16x16x32_bf16 v[72:75], v[136:139], v[192:195], v[72:75]
    ds_read2_b32 v[152:153], v248 offset0:6 offset1:4
    v_mfma_f32_16x16x32_bf16 v[76:79], v[136:139], v[196:199], v[76:79]
    global_load_dwordx4 a[188:191], v84, s[20:21] offset:0
    ds_read2_b32 v[154:155], v248 offset0:2 offset1:0
    v_mfma_f32_16x16x32_bf16 v[224:227], v[136:139], v[200:203], 0
    ds_read_b128 v[220:223], v22 offset:3776
    s_waitcnt lgkmcnt(10)
    v_mfma_f32_16x16x32_bf16 v[76:79], v[128:131], v[204:207], v[76:79]
    ds_read2_b32 v[156:157], v249 offset0:6 offset1:4
    v_mfma_f32_16x16x32_bf16 v[224:227], v[132:135], v[204:207], v[224:227]
    ds_read2_b32 v[158:159], v249 offset0:2 offset1:0
    v_mfma_f32_16x16x32_bf16 v[228:231], v[136:139], v[204:207], 0
    global_load_dwordx4 a[192:195], v84, s[20:21] offset:896
    ds_read_b128 v[96:99], v22 offset:128
    v_mfma_f32_16x16x32_bf16 v[76:79], v[140:143], v[192:195], v[76:79]
    ds_read2_b32 v[160:161], v242 offset0:38 offset1:36
    v_mfma_f32_16x16x32_bf16 v[224:227], v[140:143], v[196:199], v[224:227]
    ds_read2_b32 v[162:163], v242 offset0:34 offset1:32
    v_mfma_f32_16x16x32_bf16 v[228:231], v[140:143], v[200:203], v[228:231]
    ds_read2_b32 v[164:165], v243 offset0:38 offset1:36
    v_mfma_f32_16x16x32_bf16 v[232:235], v[140:143], v[204:207], 0
    global_load_dwordx4 a[196:199], v84, s[20:21] offset:1792
    ds_read2_b32 v[166:167], v243 offset0:34 offset1:32
    s_waitcnt lgkmcnt(14)
    v_mfma_f32_16x16x32_bf16 v[224:227], v[128:131], v[208:211], v[224:227]
    ds_read2_b32 v[168:169], v244 offset0:38 offset1:36
    v_mfma_f32_16x16x32_bf16 v[228:231], v[132:135], v[208:211], v[228:231]
    ds_read2_b32 v[170:171], v244 offset0:34 offset1:32
    v_mfma_f32_16x16x32_bf16 v[232:235], v[136:139], v[208:211], v[232:235]
    ds_read2_b32 v[172:173], v245 offset0:38 offset1:36
    v_mfma_f32_16x16x32_bf16 v[236:239], v[140:143], v[208:211], 0
    global_load_dwordx4 a[200:203], v90, s[22:23] offset:-3584
    ds_read2_b32 v[174:175], v245 offset0:34 offset1:32
    v_mfma_f32_16x16x32_bf16 v[224:227], v[144:147], v[192:195], v[224:227]
    ds_read2_b32 v[176:177], v246 offset0:38 offset1:36
    v_mfma_f32_16x16x32_bf16 v[228:231], v[144:147], v[196:199], v[228:231]
    ds_read2_b32 v[178:179], v246 offset0:34 offset1:32
    v_mfma_f32_16x16x32_bf16 v[232:235], v[144:147], v[200:203], v[232:235]
    ds_read2_b32 v[180:181], v247 offset0:38 offset1:36
    v_mfma_f32_16x16x32_bf16 v[236:239], v[144:147], v[204:207], v[236:239]
    global_load_dwordx4 a[204:207], v90, s[22:23] offset:-2688
    ds_read2_b32 v[182:183], v247 offset0:34 offset1:32
    s_waitcnt lgkmcnt(15)
    v_mfma_f32_16x16x32_bf16 v[228:231], v[128:131], v[212:215], v[228:231]
    ds_read2_b32 v[184:185], v248 offset0:38 offset1:36
    v_mfma_f32_16x16x32_bf16 v[232:235], v[132:135], v[212:215], v[232:235]
    ds_read2_b32 v[186:187], v248 offset0:34 offset1:32
    v_mfma_f32_16x16x32_bf16 v[236:239], v[136:139], v[212:215], v[236:239]
    ds_read2_b32 v[188:189], v249 offset0:38 offset1:36
    v_mfma_f32_16x16x32_bf16 v[228:231], v[148:151], v[192:195], v[228:231]
    global_load_dwordx4 a[208:211], v90, s[22:23] offset:-1792
    ds_read2_b32 v[190:191], v249 offset0:34 offset1:32
    v_mfma_f32_16x16x32_bf16 v[232:235], v[148:151], v[196:199], v[232:235]
    ds_read_b128 v[100:103], v22 offset:640
    v_mfma_f32_16x16x32_bf16 v[236:239], v[148:151], v[200:203], v[236:239]
    ds_read_b128 v[104:107], v22 offset:1152
    s_waitcnt lgkmcnt(15)
    v_mfma_f32_16x16x32_bf16 v[232:235], v[128:131], v[216:219], v[232:235]
    ds_read_b128 v[108:111], v22 offset:1664
    v_mfma_f32_16x16x32_bf16 v[236:239], v[132:135], v[216:219], v[236:239]
    global_load_dwordx4 a[212:215], v90, s[22:23] offset:-896
    ds_read_b128 v[112:115], v22 offset:2176
    v_mfma_f32_16x16x32_bf16 v[232:235], v[152:155], v[192:195], v[232:235]
    ds_read_b128 v[116:119], v22 offset:2688
    v_mfma_f32_16x16x32_bf16 v[236:239], v[152:155], v[196:199], v[236:239]
    buffer_load_dword v21, off, s[36:39], s19 offset:0 sc1
    ds_read_b128 v[120:123], v22 offset:3200
    s_waitcnt lgkmcnt(15)
    v_mfma_f32_16x16x32_bf16 v[236:239], v[128:131], v[220:223], v[236:239]
    ds_read_b128 v[124:127], v22 offset:3712
    v_mfma_f32_16x16x32_bf16 v[236:239], v[156:159], v[192:195], v[236:239]
    global_load_dwordx4 a[216:219], v90, s[22:23] offset:0
    s_waitcnt lgkmcnt(7)
    v_mfma_f32_16x16x32_bf16 v[64:67], v[160:163], v[96:99], v[64:67]
    ds_read_b128 v[192:195], v22 offset:64
    v_fma_f32 v32, v48, s52, v32
    v_mfma_f32_16x16x32_bf16 v[68:71], v[164:167], v[96:99], v[68:71]
    ds_read2_b32 v[128:129], v242 offset0:70 offset1:68
    v_fma_f32 v33, v49, s52, v33
    v_mfma_f32_16x16x32_bf16 v[72:75], v[168:171], v[96:99], v[72:75]
    ds_read2_b32 v[130:131], v242 offset0:66 offset1:64
    v_fma_f32 v34, v50, s52, v34
    v_mfma_f32_16x16x32_bf16 v[76:79], v[172:175], v[96:99], v[76:79]
    global_load_dwordx4 a[220:223], v90, s[22:23] offset:896
    ds_read2_b32 v[132:133], v243 offset0:70 offset1:68
    v_mfma_f32_16x16x32_bf16 v[224:227], v[176:179], v[96:99], v[224:227]
    ds_read2_b32 v[134:135], v243 offset0:66 offset1:64
    v_fma_f32 v35, v51, s52, v35
    v_mfma_f32_16x16x32_bf16 v[228:231], v[180:183], v[96:99], v[228:231]
    ds_write_b128 v24, v[32:35] offset:0
    v_mfma_f32_16x16x32_bf16 v[232:235], v[184:187], v[96:99], v[232:235]
    ds_read2_b32 v[136:137], v244 offset0:70 offset1:68
    v_fma_f32 v36, v52, s52, v36
    v_mfma_f32_16x16x32_bf16 v[236:239], v[188:191], v[96:99], v[236:239]
    global_load_dwordx4 a[224:227], v90, s[22:23] offset:1792
    ds_read2_b32 v[138:139], v244 offset0:66 offset1:64
    s_waitcnt lgkmcnt(8)
    v_mfma_f32_16x16x32_bf16 v[68:71], v[160:163], v[100:103], v[68:71]
    ds_read2_b32 v[140:141], v245 offset0:70 offset1:68
    v_fma_f32 v37, v53, s52, v37
    v_mfma_f32_16x16x32_bf16 v[72:75], v[164:167], v[100:103], v[72:75]
    ds_read2_b32 v[142:143], v245 offset0:66 offset1:64
    v_fma_f32 v38, v54, s52, v38
    v_mfma_f32_16x16x32_bf16 v[76:79], v[168:171], v[100:103], v[76:79]
    ds_read2_b32 v[144:145], v246 offset0:70 offset1:68
    v_fma_f32 v39, v55, s52, v39
    v_mfma_f32_16x16x32_bf16 v[224:227], v[172:175], v[100:103], v[224:227]
    global_load_dwordx4 a[228:231], v84, s[22:23] offset:-3584
    ds_write_b128 v24, v[36:39] offset:16
    v_mfma_f32_16x16x32_bf16 v[228:231], v[176:179], v[100:103], v[228:231]
    ds_read2_b32 v[146:147], v246 offset0:66 offset1:64
    v_fma_f32 v40, v56, s53, v40
    v_mfma_f32_16x16x32_bf16 v[232:235], v[180:183], v[100:103], v[232:235]
    ds_read2_b32 v[148:149], v247 offset0:70 offset1:68
    v_fma_f32 v41, v57, s53, v41
    v_mfma_f32_16x16x32_bf16 v[236:239], v[184:187], v[100:103], v[236:239]
    ds_read2_b32 v[150:151], v247 offset0:66 offset1:64
    v_fma_f32 v42, v58, s53, v42
    v_mfma_f32_16x16x32_bf16 v[72:75], v[160:163], v[104:107], v[72:75]
    global_load_dwordx4 a[232:235], v84, s[22:23] offset:-2688
    ds_read2_b32 v[152:153], v248 offset0:70 offset1:68
    v_mfma_f32_16x16x32_bf16 v[76:79], v[164:167], v[104:107], v[76:79]
    ds_read2_b32 v[154:155], v248 offset0:66 offset1:64
    v_fma_f32 v43, v59, s53, v43
    v_mfma_f32_16x16x32_bf16 v[224:227], v[168:171], v[104:107], v[224:227]
    ds_write_b128 v24, v[40:43] offset:8192
    v_mfma_f32_16x16x32_bf16 v[228:231], v[172:175], v[104:107], v[228:231]
    ds_read2_b32 v[156:157], v249 offset0:70 offset1:68
    v_fma_f32 v44, v60, s53, v44
    v_mfma_f32_16x16x32_bf16 v[232:235], v[176:179], v[104:107], v[232:235]
    global_load_dwordx4 a[236:239], v84, s[22:23] offset:-1792
    ds_read2_b32 v[158:159], v249 offset0:66 offset1:64
    v_mfma_f32_16x16x32_bf16 v[236:239], v[180:183], v[104:107], v[236:239]
    ds_read_b128 v[196:199], v22 offset:576
    v_fma_f32 v45, v61, s53, v45
    v_mfma_f32_16x16x32_bf16 v[76:79], v[160:163], v[108:111], v[76:79]
    ds_read_b128 v[200:203], v22 offset:1088
    v_fma_f32 v46, v62, s53, v46
    v_mfma_f32_16x16x32_bf16 v[224:227], v[164:167], v[108:111], v[224:227]
    ds_read_b128 v[204:207], v22 offset:1600
    v_fma_f32 v47, v63, s53, v47
    v_mfma_f32_16x16x32_bf16 v[228:231], v[168:171], v[108:111], v[228:231]
    global_load_dwordx4 a[240:243], v84, s[22:23] offset:-896
    ds_write_b128 v24, v[44:47] offset:8208
    v_mfma_f32_16x16x32_bf16 v[232:235], v[172:175], v[108:111], v[232:235]
    ds_read_b128 v[208:211], v22 offset:2112
    v_mfma_f32_16x16x32_bf16 v[236:239], v[176:179], v[108:111], v[236:239]
    ds_read_b128 v[212:215], v22 offset:2624
    v_mfma_f32_16x16x32_bf16 v[224:227], v[160:163], v[112:115], v[224:227]
    ds_read_b128 v[216:219], v22 offset:3136
    v_mfma_f32_16x16x32_bf16 v[228:231], v[164:167], v[112:115], v[228:231]
    global_load_dwordx4 a[244:247], v84, s[22:23] offset:0
    ds_read_b128 v[220:223], v22 offset:3648
    v_mfma_f32_16x16x32_bf16 v[232:235], v[168:171], v[112:115], v[232:235]
    v_mfma_f32_16x16x32_bf16 v[236:239], v[172:175], v[112:115], v[236:239]
    v_mfma_f32_16x16x32_bf16 v[228:231], v[160:163], v[116:119], v[228:231]
    v_mfma_f32_16x16x32_bf16 v[232:235], v[164:167], v[116:119], v[232:235]
    global_load_dwordx4 a[248:251], v84, s[22:23] offset:896
    v_mfma_f32_16x16x32_bf16 v[236:239], v[168:171], v[116:119], v[236:239]
    v_mfma_f32_16x16x32_bf16 v[232:235], v[160:163], v[120:123], v[232:235]
    v_mfma_f32_16x16x32_bf16 v[236:239], v[164:167], v[120:123], v[236:239]
    v_mfma_f32_16x16x32_bf16 v[236:239], v[160:163], v[124:127], v[236:239]
    global_load_dwordx4 a[252:255], v84, s[22:23] offset:1792
    s_waitcnt lgkmcnt(8)
    v_mfma_f32_16x16x32_bf16 v[64:67], v[128:131], v[192:195], v[64:67]
    ds_read_b128 v[96:99], v22 offset:0
    v_mfma_f32_16x16x32_bf16 v[68:71], v[132:135], v[192:195], v[68:71]
    s_waitcnt vmcnt(10)
    v_cmp_gt_u32 vcc, 4, v21
    s_cbranch_vccnz K_W3s0
K_W3r0:
    ds_read2_b32 v[160:161], v242 offset0:102 offset1:100
    v_mfma_f32_16x16x32_bf16 v[72:75], v[136:139], v[192:195], v[72:75]
    ds_read2_b32 v[162:163], v242 offset0:98 offset1:96
    v_mfma_f32_16x16x32_bf16 v[76:79], v[140:143], v[192:195], v[76:79]
    buffer_load_dwordx4 a[0:3], v95, s[36:39], s58 offen offset:0 sc1
    ds_read2_b32 v[164:165], v243 offset0:102 offset1:100
    v_mfma_f32_16x16x32_bf16 v[224:227], v[144:147], v[192:195], v[224:227]
    ds_read2_b32 v[166:167], v243 offset0:98 offset1:96
    v_mfma_f32_16x16x32_bf16 v[228:231], v[148:151], v[192:195], v[228:231]
    ds_read2_b32 v[168:169], v244 offset0:102 offset1:100
    v_mfma_f32_16x16x32_bf16 v[232:235], v[152:155], v[192:195], v[232:235]
    ds_read2_b32 v[170:171], v244 offset0:98 offset1:96
    v_mfma_f32_16x16x32_bf16 v[236:239], v[156:159], v[192:195], v[236:239]
    buffer_load_dwordx4 a[4:7], v95, s[36:39], s58 offen offset:1024 sc1
    ds_read2_b32 v[172:173], v245 offset0:102 offset1:100
    s_waitcnt lgkmcnt(8)
    v_mfma_f32_16x16x32_bf16 v[68:71], v[128:131], v[196:199], v[68:71]
    ds_read2_b32 v[174:175], v245 offset0:98 offset1:96
    v_mfma_f32_16x16x32_bf16 v[72:75], v[132:135], v[196:199], v[72:75]
    ds_read2_b32 v[176:177], v246 offset0:102 offset1:100
    v_mfma_f32_16x16x32_bf16 v[76:79], v[136:139], v[196:199], v[76:79]
    ds_read2_b32 v[178:179], v246 offset0:98 offset1:96
    v_mfma_f32_16x16x32_bf16 v[224:227], v[140:143], v[196:199], v[224:227]
    buffer_load_dwordx4 a[8:11], v95, s[36:39], s58 offen offset:2048 sc1
    ds_read2_b32 v[180:181], v247 offset0:102 offset1:100
    v_mfma_f32_16x16x32_bf16 v[228:231], v[144:147], v[196:199], v[228:231]
    ds_read2_b32 v[182:183], v247 offset0:98 offset1:96
    v_mfma_f32_16x16x32_bf16 v[232:235], v[148:151], v[196:199], v[232:235]
    ds_read2_b32 v[184:185], v248 offset0:102 offset1:100
    v_mfma_f32_16x16x32_bf16 v[236:239], v[152:155], v[196:199], v[236:239]
    ds_read2_b32 v[186:187], v248 offset0:98 offset1:96
    v_mfma_f32_16x16x32_bf16 v[72:75], v[128:131], v[200:203], v[72:75]
    buffer_load_dwordx4 a[12:15], v95, s[36:39], s58 offen offset:3072 sc1
    ds_read2_b32 v[188:189], v249 offset0:102 offset1:100
    v_mfma_f32_16x16x32_bf16 v[76:79], v[132:135], v[200:203], v[76:79]
    ds_read2_b32 v[190:191], v249 offset0:98 offset1:96
    v_mfma_f32_16x16x32_bf16 v[224:227], v[136:139], v[200:203], v[224:227]
    ds_read_b128 v[100:103], v22 offset:512
    v_mfma_f32_16x16x32_bf16 v[228:231], v[140:143], v[200:203], v[228:231]
    ds_read_b128 v[104:107], v22 offset:1024
    v_mfma_f32_16x16x32_bf16 v[232:235], v[144:147], v[200:203], v[232:235]
    s_add_u32 s58, s58, 4096
    buffer_load_dwordx4 a[16:19], v95, s[36:39], s58 offen offset:0 sc1
    ds_read_b128 v[108:111], v22 offset:1536
    v_mfma_f32_16x16x32_bf16 v[236:239], v[148:151], v[200:203], v[236:239]
    ds_read_b128 v[112:115], v22 offset:2048
    v_mfma_f32_16x16x32_bf16 v[76:79], v[128:131], v[204:207], v[76:79]
    ds_read_b128 v[116:119], v22 offset:2560
    v_mfma_f32_16x16x32_bf16 v[224:227], v[132:135], v[204:207], v[224:227]
    ds_read_b128 v[120:123], v22 offset:3072
    v_mfma_f32_16x16x32_bf16 v[228:231], v[136:139], v[204:207], v[228:231]
    buffer_load_dwordx4 a[20:23], v95, s[36:39], s58 offen offset:1024 sc1
    ds_read_b128 v[124:127], v22 offset:3584
    v_mfma_f32_16x16x32_bf16 v[232:235], v[140:143], v[204:207], v[232:235]
    v_mfma_f32_16x16x32_bf16 v[236:239], v[144:147], v[204:207], v[236:239]
    v_mfma_f32_16x16x32_bf16 v[224:227], v[128:131], v[208:211], v[224:227]
    v_mfma_f32_16x16x32_bf16 v[228:231], v[132:135], v[208:211], v[228:231]
    buffer_load_dwordx4 a[24:27], v95, s[36:39], s58 offen offset:2048 sc1
    v_mfma_f32_16x16x32_bf16 v[232:235], v[136:139], v[208:211], v[232:235]
    v_mfma_f32_16x16x32_bf16 v[236:239], v[140:143], v[208:211], v[236:239]
    v_mfma_f32_16x16x32_bf16 v[228:231], v[128:131], v[212:215], v[228:231]
    v_mfma_f32_16x16x32_bf16 v[232:235], v[132:135], v[212:215], v[232:235]
    buffer_load_dwordx4 a[28:31], v95, s[36:39], s58 offen offset:3072 sc1
    v_mfma_f32_16x16x32_bf16 v[236:239], v[136:139], v[212:215], v[236:239]
    v_mfma_f32_16x16x32_bf16 v[232:235], v[128:131], v[216:219], v[232:235]
    v_mfma_f32_16x16x32_bf16 v[236:239], v[132:135], v[216:219], v[236:239]
    v_mfma_f32_16x16x32_bf16 v[236:239], v[128:131], v[220:223], v[236:239]
    s_add_u32 s58, s58, 4096
    buffer_load_dwordx4 a[32:35], v95, s[36:39], s58 offen offset:0 sc1
    s_cmp_eq_u32 s40, 0
    s_cbranch_scc0 K_EH1
    s_waitcnt lgkmcnt(0)
    v_mfma_f32_16x16x32_bf16 v[68:71], v[164:167], v[96:99], v[68:71]
    v_mfma_f32_16x16x32_bf16 v[68:71], v[160:163], v[100:103], v[68:71]
    v_mfma_f32_16x16x32_bf16 v[72:75], v[168:171], v[96:99], v[72:75]
    v_mfma_f32_16x16x32_bf16 v[72:75], v[164:167], v[100:103], v[72:75]
    buffer_load_dwordx4 a[36:39], v95, s[36:39], s58 offen offset:1024 sc1
    v_mfma_f32_16x16x32_bf16 v[72:75], v[160:163], v[104:107], v[72:75]
    s_barrier
    v_mfma_f32_16x16x32_bf16 v[228:231], v[180:183], v[96:99], v[228:231]
    v_mfma_f32_16x16x32_bf16 v[228:231], v[176:179], v[100:103], v[228:231]
    v_mfma_f32_16x16x32_bf16 v[228:231], v[172:175], v[104:107], v[228:231]
    buffer_load_dwordx4 a[40:43], v95, s[36:39], s58 offen offset:2048 sc1
    v_mfma_f32_16x16x32_bf16 v[228:231], v[168:171], v[108:111], v[228:231]
    v_mfma_f32_16x16x32_bf16 v[228:231], v[164:167], v[112:115], v[228:231]
    ds_write_b128 v26, v[68:71] offset:0
    v_mfma_f32_16x16x32_bf16 v[228:231], v[160:163], v[116:119], v[228:231]
    v_mfma_f32_16x16x32_bf16 v[232:235], v[184:187], v[96:99], v[232:235]
    buffer_load_dwordx4 a[44:47], v95, s[36:39], s58 offen offset:3072 sc1
    v_mfma_f32_16x16x32_bf16 v[232:235], v[180:183], v[100:103], v[232:235]
    v_mfma_f32_16x16x32_bf16 v[232:235], v[176:179], v[104:107], v[232:235]
    ds_write_b128 v26, v[72:75] offset:1024
    v_mfma_f32_16x16x32_bf16 v[232:235], v[172:175], v[108:111], v[232:235]
    v_mfma_f32_16x16x32_bf16 v[232:235], v[168:171], v[112:115], v[232:235]
    s_add_u32 s58, s58, 4096
    buffer_load_dwordx4 a[48:51], v95, s[36:39], s58 offen offset:0 sc1
    v_mfma_f32_16x16x32_bf16 v[232:235], v[164:167], v[116:119], v[232:235]
    v_mfma_f32_16x16x32_bf16 v[232:235], v[160:163], v[120:123], v[232:235]
    ds_write_b128 v26, v[228:231] offset:2048
    v_mfma_f32_16x16x32_bf16 v[64:67], v[160:163], v[96:99], v[64:67]
    v_mfma_f32_16x16x32_bf16 v[76:79], v[172:175], v[96:99], v[76:79]
    buffer_load_dwordx4 a[52:55], v95, s[36:39], s58 offen offset:1024 sc1
    v_mfma_f32_16x16x32_bf16 v[76:79], v[168:171], v[100:103], v[76:79]
    v_mfma_f32_16x16x32_bf16 v[76:79], v[164:167], v[104:107], v[76:79]
    s_nop 1
    ds_write_b128 v26, v[232:235] offset:3072
    v_mfma_f32_16x16x32_bf16 v[76:79], v[160:163], v[108:111], v[76:79]
    v_mfma_f32_16x16x32_bf16 v[224:227], v[176:179], v[96:99], v[224:227]
    v_mfma_f32_16x16x32_bf16 v[224:227], v[172:175], v[100:103], v[224:227]
    s_waitcnt lgkmcnt(0)
    s_barrier
    v_mfma_f32_16x16x32_bf16 v[224:227], v[168:171], v[104:107], v[224:227]
    ds_read_b128 v[48:51], v27 offset:0
    ds_read_b128 v[32:35], v25 offset:0
    v_mfma_f32_16x16x32_bf16 v[224:227], v[164:167], v[108:111], v[224:227]
    ds_read_b128 v[52:55], v27 offset:1024
    ds_read_b128 v[36:39], v25 offset:3072
    v_mfma_f32_16x16x32_bf16 v[224:227], v[160:163], v[112:115], v[224:227]
    ds_read_b128 v[56:59], v27 offset:2048
    ds_read_b128 v[40:43], v25 offset:4096
    v_mfma_f32_16x16x32_bf16 v[236:239], v[188:191], v[96:99], v[236:239]
    ds_read_b128 v[60:63], v27 offset:3072
    ds_read_b128 v[44:47], v25 offset:7168
    v_mfma_f32_16x16x32_bf16 v[236:239], v[184:187], v[100:103], v[236:239]
    v_mfma_f32_16x16x32_bf16 v[236:239], v[180:183], v[104:107], v[236:239]
    v_mfma_f32_16x16x32_bf16 v[236:239], v[176:179], v[108:111], v[236:239]
    v_mfma_f32_16x16x32_bf16 v[236:239], v[172:175], v[112:115], v[236:239]
    v_mfma_f32_16x16x32_bf16 v[236:239], v[168:171], v[116:119], v[236:239]
    v_mfma_f32_16x16x32_bf16 v[236:239], v[164:167], v[120:123], v[236:239]
    v_mfma_f32_16x16x32_bf16 v[236:239], v[160:163], v[124:127], v[236:239]
    s_waitcnt lgkmcnt(0)
    s_nop 0
    v_pk_add_f32 v[32:33], v[32:33], v[48:49]
    v_pk_add_f32 v[34:35], v[34:35], v[50:51]
    v_pk_add_f32 v[36:37], v[36:37], v[52:53]
    v_pk_add_f32 v[38:39], v[38:39], v[54:55]
    v_pk_add_f32 v[40:41], v[40:41], v[56:57]
    v_pk_add_f32 v[42:43], v[42:43], v[58:59]
    v_pk_add_f32 v[44:45], v[44:45], v[60:61]
    v_pk_add_f32 v[46:47], v[46:47], v[62:63]
    v_pk_add_f32 v[32:33], v[32:33], v[64:65]
    v_pk_add_f32 v[34:35], v[34:35], v[66:67]
    v_pk_add_f32 v[36:37], v[36:37], v[76:77]
    v_pk_add_f32 v[38:39], v[38:39], v[78:79]
    v_pk_add_f32 v[40:41], v[40:41], v[224:225]
    v_pk_add_f32 v[42:43], v[42:43], v[226:227]
    v_pk_add_f32 v[44:45], v[44:45], v[236:237]
    v_pk_add_f32 v[46:47], v[46:47], v[238:239]
    s_branch K_ED
K_EH1:
    s_waitcnt lgkmcnt(0)
    v_mfma_f32_16x16x32_bf16 v[64:67], v[160:163], v[96:99], v[64:67]
    v_mfma_f32_16x16x32_bf16 v[76:79], v[172:175], v[96:99], v[76:79]
    v_mfma_f32_16x16x32_bf16 v[76:79], v[168:171], v[100:103], v[76:79]
    v_mfma_f32_16x16x32_bf16 v[76:79], v[164:167], v[104:107], v[76:79]
    buffer_load_dwordx4 a[36:39], v95, s[36:39], s58 offen offset:1024 sc1
    v_mfma_f32_16x16x32_bf16 v[76:79], v[160:163], v[108:111], v[76:79]
    s_barrier
    v_mfma_f32_16x16x32_bf16 v[224:227], v[176:179], v[96:99], v[224:227]
    v_mfma_f32_16x16x32_bf16 v[224:227], v[172:175], v[100:103], v[224:227]
    v_mfma_f32_16x16x32_bf16 v[224:227], v[168:171], v[104:107], v[224:227]
    buffer_load_dwordx4 a[40:43], v95, s[36:39], s58 offen offset:2048 sc1
    v_mfma_f32_16x16x32_bf16 v[224:227], v[164:167], v[108:111], v[224:227]
    v_mfma_f32_16x16x32_bf16 v[224:227], v[160:163], v[112:115], v[224:227]
    ds_write_b128 v26, v[64:67] offset:0
    v_mfma_f32_16x16x32_bf16 v[236:239], v[188:191], v[96:99], v[236:239]
    v_mfma_f32_16x16x32_bf16 v[236:239], v[184:187], v[100:103], v[236:239]
    buffer_load_dwordx4 a[44:47], v95, s[36:39], s58 offen offset:3072 sc1
    v_mfma_f32_16x16x32_bf16 v[236:239], v[180:183], v[104:107], v[236:239]
    v_mfma_f32_16x16x32_bf16 v[236:239], v[176:179], v[108:111], v[236:239]
    ds_write_b128 v26, v[76:79] offset:1024
    v_mfma_f32_16x16x32_bf16 v[236:239], v[172:175], v[112:115], v[236:239]
    v_mfma_f32_16x16x32_bf16 v[236:239], v[168:171], v[116:119], v[236:239]
    s_add_u32 s58, s58, 4096
    buffer_load_dwordx4 a[48:51], v95, s[36:39], s58 offen offset:0 sc1
    v_mfma_f32_16x16x32_bf16 v[236:239], v[164:167], v[120:123], v[236:239]
    v_mfma_f32_16x16x32_bf16 v[236:239], v[160:163], v[124:127], v[236:239]
    ds_write_b128 v26, v[224:227] offset:2048
    v_mfma_f32_16x16x32_bf16 v[68:71], v[164:167], v[96:99], v[68:71]
    v_mfma_f32_16x16x32_bf16 v[68:71], v[160:163], v[100:103], v[68:71]
    buffer_load_dwordx4 a[52:55], v95, s[36:39], s58 offen offset:1024 sc1
    v_mfma_f32_16x16x32_bf16 v[72:75], v[168:171], v[96:99], v[72:75]
    v_mfma_f32_16x16x32_bf16 v[72:75], v[164:167], v[100:103], v[72:75]
    s_nop 1
    ds_write_b128 v26, v[236:239] offset:3072
    v_mfma_f32_16x16x32_bf16 v[72:75], v[160:163], v[104:107], v[72:75]
    v_mfma_f32_16x16x32_bf16 v[228:231], v[180:183], v[96:99], v[228:231]
    v_mfma_f32_16x16x32_bf16 v[228:231], v[176:179], v[100:103], v[228:231]
    s_waitcnt lgkmcnt(0)
    s_barrier
    v_mfma_f32_16x16x32_bf16 v[228:231], v[172:175], v[104:107], v[228:231]
    ds_read_b128 v[48:51], v27 offset:0
    ds_read_b128 v[32:35], v25 offset:1024
    v_mfma_f32_16x16x32_bf16 v[228:231], v[168:171], v[108:111], v[228:231]
    ds_read_b128 v[52:55], v27 offset:1024
    ds_read_b128 v[36:39], v25 offset:2048
    v_mfma_f32_16x16x32_bf16 v[228:231], v[164:167], v[112:115], v[228:231]
    ds_read_b128 v[56:59], v27 offset:2048
    ds_read_b128 v[40:43], v25 offset:5120
    v_mfma_f32_16x16x32_bf16 v[228:231], v[160:163], v[116:119], v[228:231]
    ds_read_b128 v[60:63], v27 offset:3072
    ds_read_b128 v[44:47], v25 offset:6144
    v_mfma_f32_16x16x32_bf16 v[232:235], v[184:187], v[96:99], v[232:235]
    v_mfma_f32_16x16x32_bf16 v[232:235], v[180:183], v[100:103], v[232:235]
    v_mfma_f32_16x16x32_bf16 v[232:235], v[176:179], v[104:107], v[232:235]
    v_mfma_f32_16x16x32_bf16 v[232:235], v[172:175], v[108:111], v[232:235]
    v_mfma_f32_16x16x32_bf16 v[232:235], v[168:171], v[112:115], v[232:235]
    v_mfma_f32_16x16x32_bf16 v[232:235], v[164:167], v[116:119], v[232:235]
    v_mfma_f32_16x16x32_bf16 v[232:235], v[160:163], v[120:123], v[232:235]
    s_waitcnt lgkmcnt(0)
    s_nop 0
    v_pk_add_f32 v[32:33], v[32:33], v[48:49]
    v_pk_add_f32 v[34:35], v[34:35], v[50:51]
    v_pk_add_f32 v[36:37], v[36:37], v[52:53]
    v_pk_add_f32 v[38:39], v[38:39], v[54:55]
    v_pk_add_f32 v[40:41], v[40:41], v[56:57]
    v_pk_add_f32 v[42:43], v[42:43], v[58:59]
    v_pk_add_f32 v[44:45], v[44:45], v[60:61]
    v_pk_add_f32 v[46:47], v[46:47], v[62:63]
    v_pk_add_f32 v[32:33], v[32:33], v[68:69]
    v_pk_add_f32 v[34:35], v[34:35], v[70:71]
    v_pk_add_f32 v[36:37], v[36:37], v[72:73]
    v_pk_add_f32 v[38:39], v[38:39], v[74:75]
    v_pk_add_f32 v[40:41], v[40:41], v[228:229]
    v_pk_add_f32 v[42:43], v[42:43], v[230:231]
    v_pk_add_f32 v[44:45], v[44:45], v[232:233]
    v_pk_add_f32 v[46:47], v[46:47], v[234:235]
K_ED:
    v_cvt_pk_bf16_f32 v80, v32, v33
    v_cvt_pk_bf16_f32 v81, v34, v35
    v_cvt_pk_bf16_f32 v82, v36, v37
    v_cvt_pk_bf16_f32 v83, v38, v39
    v_cvt_pk_bf16_f32 v84, v40, v41
    v_cvt_pk_bf16_f32 v85, v42, v43
    v_cvt_pk_bf16_f32 v86, v44, v45
    v_cvt_pk_bf16_f32 v87, v46, v47
    v_permlane16_swap_b32 v80, v82
    v_permlane16_swap_b32 v81, v83
    global_store_dwordx4 v28, v[80:83], s[32:33] sc1
    v_permlane16_swap_b32 v84, v86
    v_permlane16_swap_b32 v85, v87
    global_store_dwordx4 v31, v[84:87], s[32:33] sc1
    v_lshrrev_b32 v20, 3, v1
    v_and_b32 v21, 1, v20
    v_mul_u32_u24 v20, 1792, v20
    v_and_b32 v22, 0x70, v95
    v_lshlrev_b32 v21, 6, v21
    v_xor_b32 v22, v22, v21
    s_mul_i32 s3, s34, 14336
    s_add_u32 s3, s3, 106496
    v_add3_u32 v124, v20, v22, s3
    v_xor_b32 v125, 64, v124
    s_waitcnt vmcnt(16)
    ds_write_b128 v124, a[144:147] offset:0
    buffer_load_dwordx4 a[56:59], v95, s[36:39], s58 offen offset:2048 sc1
    v_lshlrev_b32 v2, 4, v1
    v_and_b32 v3, 0x380, v2
    v_add_u32 v3, v3, v91
    s_lshl_b32 s3, s40, 6
    v_xor_b32 v26, s3, v94
    s_lshl_b32 s11, s40, 12
    v_add_u32 v250, 106496, v26
    v_add_u32 v248, s11, v250
    ds_write_b128 v124, a[148:151] offset:128
    v_subrev_u32 v249, s11, v250
    v_add_u32 v249, 4096, v249
    s_mul_i32 s15, s34, 17408
    s_add_u32 s15, s15, 90112
    s_lshl_b32 s3, s35, 6
    v_xor_b32 v251, s3, v94
    v_add_u32 v4, s11, v251
    v_subrev_u32 v5, s11, v251
    ds_write_b128 v125, a[152:155] offset:256
    buffer_load_dwordx4 a[60:63], v95, s[36:39], s58 offen offset:3072 sc1
    v_add_u32 v5, 4096, v5
    s_lshl_b32 s3, s35, 10
    v_add_u32 v6, s3, v2
    s_lshl_b32 s16, s43, 2
    s_lshl_b32 s3, s40, 1
    s_add_u32 s16, s16, s3
    s_lshl_b32 s3, s16, 11
    v_add_u32 v251, s3, v251
    ds_write_b128 v125, a[156:159] offset:384
    s_lshl_b32 s17, s42, 6
    s_lshl_b32 s3, s35, 5
    s_add_u32 s17, s17, s3
    v_and_b32 v27, 31, v1
    v_lshrrev_b32 v28, 5, v1
    v_and_b32 v7, 7, v1
    s_and_b32 s3, s41, 31
    s_lshl_b32 s3, s3, 11
    ds_write_b128 v124, a[160:163] offset:512
    s_add_u32 s58, s58, 4096
    buffer_load_dwordx4 a[64:67], v95, s[36:39], s58 offen offset:0 sc1
    s_add_u32 s3, s3, 65536
    v_lshl_add_u32 v15, v7, 8, s3
    v_min_u32 v7, 6, v7
    v_lshlrev_b32 v7, 2, v7
    s_lshr_b32 s54, s34, 1
    s_add_u32 s54, s54, 1
    s_lshl_b32 s55, s40, 1
    s_sub_u32 s55, s55, 1
    ds_write_b128 v124, a[164:167] offset:640
    s_mul_i32 s54, s54, s55
    s_lshl_b32 s55, s42, 6
    s_add_u32 s54, s54, s55
    v_add_u32 v29, s54, v27
    v_and_b32 v30, 31, v29
    v_lshlrev_b32 v30, 4, v30
    v_lshl_add_u32 v31, v28, 9, v30
    s_mul_i32 s52, s42, 57344
    ds_write_b128 v125, a[168:171] offset:768
    buffer_load_dwordx4 a[68:71], v95, s[36:39], s58 offen offset:1024 sc1
    s_lshl_b32 s53, s16, 11
    s_add_u32 s52, s52, s53
    s_add_u32 s12, s52, 2883584
    v_bfe_u32 v30, v29, 6, 5
    v_mul_u32_u24 v13, 57344, v30
    v_bfe_u32 v30, v29, 5, 1
    v_lshl_add_u32 v13, v30, 10, v13
    v_lshrrev_b32 v30, 11, v29
    ds_write_b128 v125, a[172:175] offset:896
    v_min_u32 v30, 1, v30
    v_lshl_add_u32 v13, v30, 30, v13
    v_add_u32 v13, v13, v31
    v_add_u32 v13, 2883584, v13
    v_add_u32 v29, 32, v29
    v_bfe_u32 v30, v29, 6, 5
    v_mul_u32_u24 v14, 57344, v30
    v_bfe_u32 v30, v29, 5, 1
    ds_write_b128 v124, a[176:179] offset:1024
    v_lshl_add_u32 v14, v30, 10, v14
    v_lshrrev_b32 v30, 11, v29
    v_min_u32 v30, 1, v30
    v_lshl_add_u32 v14, v30, 30, v14
    v_add_u32 v14, v14, v31
    v_add_u32 v14, 2882560, v14
    s_lshl_b32 s52, s42, 16
    s_add_u32 s52, s52, 4718592
    ds_write_b128 v124, a[180:183] offset:1152
    s_mul_i32 s53, s35, 35840
    s_lshl_b32 s54, s16, 10
    s_add_u32 s53, s53, s54
    s_add_u32 s53, s53, s52
    v_add_u32 v17, s53, v2
    s_lshl_b32 s53, s43, 10
    s_add_u32 s53, s53, s52
    s_lshl_b32 s54, s35, 8
    ds_write_b128 v125, a[184:187] offset:1280
    s_add_u32 s53, s53, s54
    s_lshl_b32 s54, s40, 9
    s_add_u32 s53, s53, s54
    s_add_u32 s53, s53, 28672
    v_lshlrev_b32 v18, 3, v27
    v_lshl_add_u32 v18, v28, 2, v18
    v_add_u32 v18, s53, v18
    s_lshl_b32 s53, s42, 6
    ds_write_b128 v125, a[188:191] offset:1408
    v_lshrrev_b32 v16, 3, v0
    v_add_u32 v16, s53, v16
    v_mul_u32_u24 v16, 896, v16
    v_and_b32 v31, 0x70, v2
    s_lshl_b32 s53, s43, 7
    v_add3_u32 v16, v16, v31, s53
    s_mul_i32 s53, s43, 229376
    s_lshl_b32 s54, s34, 13
    ds_write_b128 v124, a[192:195] offset:1536
    s_add_u32 s53, s53, s54
    s_add_u32 s53, s53, 8421376
    v_add_u32 v8, s53, v2
    v_add_u32 v9, 4096, v8
    s_mul_i32 s53, s42, 229376
    s_add_u32 s53, s53, s54
    s_add_u32 s53, s53, 10223616
    v_add_u32 v10, s53, v2
    ds_write_b128 v124, a[196:199] offset:1664
    v_add_u32 v11, 4096, v10
    s_mul_i32 s53, s34, 4352
    s_add_u32 s53, s53, 65536
    v_add_u32 v19, s53, v2
    s_lshl_b32 s18, s42, 7
    s_lshl_b32 s19, s43, 2
    s_add_u32 s19, s19, s18
    s_add_u32 s19, s19, 19607552
    s_lshl_b32 s56, s44, 8
    s_add_u32 s56, s56, 65536
    s_add_u32 s56, s56, s45
    v_mov_b32 v12, 1
    v_lshlrev_b32 v23, 11, v1
    s_waitcnt vmcnt(4) lgkmcnt(0)
K_PGA2:
    s_cbranch_execz K_WRA
    s_nop 0
    s_barrier
    s_mov_b32 exec_hi, 0
    buffer_atomic_add v12, v23, s[36:39], s56 offen sc1
    s_mov_b64 exec, -1
    buffer_load_dwordx4 a[72:75], v2, s[36:39], s58 offen offset:2048 sc1
    s_lshl_b32 s53, s43, 2
    s_add_u32 s53, s53, s34
    s_lshl_b32 s49, s53, 8
    s_add_u32 s49, s49, 262144
    s_lshl_b32 s14, s43, 7
    s_add_u32 s14, s14, 24576
    s_lshl_b32 s13, s43, 8
    buffer_load_dwordx4 a[76:79], v2, s[36:39], s58 offen offset:3072 sc1
    s_add_u32 s13, s13, 269312
    s_mul_i32 s51, s42, 57344
    s_lshl_b32 s53, s34, 11
    s_add_u32 s51, s51, s53
    s_add_u32 s51, s51, 1048576
    s_add_u32 s53, s43, 0
    s_sub_u32 s54, s53, 7
    s_add_u32 s58, s58, 4096
    buffer_load_dwordx4 a[80:83], v2, s[36:39], s58 offen offset:0 sc1
    s_min_u32 s53, s53, s54
    s_lshl_b32 s4, s53, 15
    s_add_u32 s53, s43, 1
    s_sub_u32 s54, s53, 7
    s_min_u32 s53, s53, s54
    s_lshl_b32 s5, s53, 15
    s_add_u32 s53, s43, 2
    buffer_load_dwordx4 a[84:87], v2, s[36:39], s58 offen offset:1024 sc1
    s_sub_u32 s54, s53, 7
    s_min_u32 s53, s53, s54
    s_lshl_b32 s6, s53, 15
    s_add_u32 s53, s43, 3
    s_sub_u32 s54, s53, 7
    s_min_u32 s53, s53, s54
    s_lshl_b32 s7, s53, 15
    buffer_load_dwordx4 a[88:91], v2, s[36:39], s58 offen offset:2048 sc1
    s_add_u32 s53, s43, 4
    s_sub_u32 s54, s53, 7
    s_min_u32 s53, s53, s54
    s_lshl_b32 s8, s53, 15
    s_add_u32 s53, s43, 5
    s_sub_u32 s54, s53, 7
    s_min_u32 s53, s53, s54
    buffer_load_dwordx4 a[92:95], v2, s[36:39], s58 offen offset:3072 sc1
    s_lshl_b32 s9, s53, 15
    s_add_u32 s53, s43, 6
    s_sub_u32 s54, s53, 7
    s_min_u32 s53, s53, s54
    s_lshl_b32 s10, s53, 15
    ds_read_b64_tr_b16 v[128:129], v248 offset:0
    ds_read_b64_tr_b16 v[130:131], v248 offset:1024
    s_add_u32 s58, s58, 4096
    buffer_load_dwordx4 a[96:99], v2, s[36:39], s58 offen offset:0 sc1
    ds_read_b64_tr_b16 v[132:133], v248 offset:2048
    ds_read_b64_tr_b16 v[134:135], v248 offset:3072
    ds_read_b64_tr_b16 v[136:137], v249 offset:0
    ds_read_b64_tr_b16 v[138:139], v249 offset:1024
    ds_read_b64_tr_b16 v[140:141], v249 offset:2048
    ds_read_b64_tr_b16 v[142:143], v249 offset:3072
    ds_read_b64_tr_b16 v[144:145], v248 offset:8192
    buffer_load_dwordx4 a[100:103], v2, s[36:39], s58 offen offset:1024 sc1
    ds_read_b64_tr_b16 v[146:147], v248 offset:9216
    ds_read_b64_tr_b16 v[148:149], v248 offset:10240
    ds_read_b64_tr_b16 v[150:151], v248 offset:11264
    ds_read_b64_tr_b16 v[152:153], v249 offset:8192
    ds_read_b64_tr_b16 v[154:155], v249 offset:9216
    ds_read_b64_tr_b16 v[156:157], v249 offset:10240
    ds_read_b64_tr_b16 v[158:159], v249 offset:11264
    buffer_load_dwordx4 a[104:107], v2, s[36:39], s58 offen offset:2048 sc1
    ds_read_b64_tr_b16 v[160:161], v248 offset:16384
    ds_read_b64_tr_b16 v[162:163], v248 offset:17408
    ds_read_b64_tr_b16 v[164:165], v248 offset:18432
    ds_read_b64_tr_b16 v[166:167], v248 offset:19456
    ds_read_b64_tr_b16 v[168:169], v249 offset:16384
    ds_read_b64_tr_b16 v[170:171], v249 offset:17408
    ds_read_b64_tr_b16 v[172:173], v249 offset:18432
    buffer_load_dwordx4 a[108:111], v2, s[36:39], s58 offen offset:3072 sc1
    ds_read_b64_tr_b16 v[174:175], v249 offset:19456
    ds_read_b64_tr_b16 v[176:177], v248 offset:24576
    ds_read_b64_tr_b16 v[178:179], v248 offset:25600
    ds_read_b64_tr_b16 v[180:181], v248 offset:26624
    ds_read_b64_tr_b16 v[182:183], v248 offset:27648
    ds_read_b64_tr_b16 v[184:185], v249 offset:24576
    ds_read_b64_tr_b16 v[186:187], v249 offset:25600
    ds_read_b64_tr_b16 v[188:189], v249 offset:26624
    ds_read_b64_tr_b16 v[190:191], v249 offset:27648
    ds_read_b64_tr_b16 v[192:193], v248 offset:32768
    ds_read_b64_tr_b16 v[194:195], v248 offset:33792
    ds_read_b64_tr_b16 v[196:197], v248 offset:34816
    ds_read_b64_tr_b16 v[198:199], v248 offset:35840
    ds_read_b64_tr_b16 v[200:201], v249 offset:32768
    ds_read_b64_tr_b16 v[202:203], v249 offset:33792
    ds_read_b64_tr_b16 v[204:205], v249 offset:34816
    ds_read_b64_tr_b16 v[206:207], v249 offset:35840
    ds_read_b64_tr_b16 v[208:209], v248 offset:40960
    ds_read_b64_tr_b16 v[210:211], v248 offset:41984
    ds_read_b64_tr_b16 v[212:213], v248 offset:43008
    ds_read_b64_tr_b16 v[214:215], v248 offset:44032
    ds_read_b64_tr_b16 v[216:217], v249 offset:40960
    ds_read_b64_tr_b16 v[218:219], v249 offset:41984
    ds_read_b64_tr_b16 v[220:221], v249 offset:43008
    ds_read_b64_tr_b16 v[222:223], v249 offset:44032
    ds_read_b64_tr_b16 v[224:225], v248 offset:49152
    ds_read_b64_tr_b16 v[226:227], v248 offset:50176
    ds_read_b64_tr_b16 v[228:229], v248 offset:51200
    ds_read_b64_tr_b16 v[230:231], v248 offset:52224
    ds_read_b64_tr_b16 v[232:233], v249 offset:49152
    ds_read_b64_tr_b16 v[234:235], v249 offset:50176
    ds_read_b64_tr_b16 v[236:237], v249 offset:51200
    ds_read_b64_tr_b16 v[238:239], v249 offset:52224
    v_mov_b32 v12, 0
    s_mov_b64 exec, 255
    buffer_atomic_add v12, v15, s[36:39], s45 offen sc0 sc1
    s_mov_b64 exec, -1
    s_lshl_b32 m0, s34, 11
    s_mov_b64 exec, 0
    s_cmp_eq_u32 s34, 0
    s_cbranch_scc1 K_PGB0
    s_cmp_eq_u32 s34, 1
    s_cbranch_scc1 K_PGB1
    s_cmp_eq_u32 s34, 2
    s_cbranch_scc1 K_PGB2
    s_cmp_eq_u32 s34, 3
    s_cbranch_scc1 K_PGB3
K_WRB:
    s_mov_b64 exec, -1
    s_cmp_lg_u32 s34, 0
    s_cbranch_scc1 K_AS_1e
    s_mov_b32 s54, 1048576
    s_mov_b64 exec, 255
    s_waitcnt vmcnt(0)
    v_cmp_gt_u32 vcc, 32, v12
    s_cbranch_vccz K_AS_1x
K_AS_1:
    v_mov_b32 v12, 0
    buffer_atomic_add v12, v15, s[36:39], 0 offen sc0 sc1
    s_sub_u32 s54, s54, 1
    s_cselect_b32 s55, 0, 32
    s_waitcnt vmcnt(0)
    v_cmp_gt_u32 vcc, s55, v12
    s_cbranch_vccz K_AS_1x
    v_mov_b32 v12, 0
    buffer_atomic_add v12, v15, s[36:39], 0 offen sc0 sc1
    s_sub_u32 s54, s54, 1
    s_cselect_b32 s55, 0, 32
    s_waitcnt vmcnt(0)
    v_cmp_gt_u32 vcc, s55, v12
    s_cbranch_vccz K_AS_1x
    s_branch K_AS_1
K_AS_1x:
    s_mov_b64 exec, -1
K_AS_1e:
    s_barrier
    buffer_load_dwordx4 v3, s[36:39], s51 offen offset:0 sc1 lds
    buffer_load_dwordx4 v3, s[36:39], s51 offen offset:1024 sc1 lds
    s_add_u32 m0, m0, 8192
    s_add_u32 s51, s51, 8192
    buffer_load_dwordx4 v3, s[36:39], s51 offen offset:0 sc1 lds
    v_lshlrev_b32 v21, 2, v1
    buffer_load_dword v20, v21, s[36:39], s13 offen sc1
    buffer_load_dword v24, v21, s[36:39], s49 offen sc1
    v_mov_b32 v122, 0
    buffer_load_dwordx4 v3, s[36:39], s51 offen offset:1024 sc1 lds
    s_add_u32 m0, m0, 8192
    s_add_u32 s51, s51, 8192
    v_mov_b32 v123, 0
    v_mov_b32 v242, 0
    v_mov_b32 v243, 0
    s_lshl_b32 s53, s18, 3
    buffer_load_dwordx4 v3, s[36:39], s51 offen offset:0 sc1 lds
    s_add_u32 s53, s53, 19607552
    v_lshl_add_u32 v15, v1, 8, s53
    s_add_u32 s53, s42, 31
    v_add_u32 v255, s53, v1
    buffer_load_dwordx4 v3, s[36:39], s51 offen offset:1024 sc1 lds
    s_add_u32 m0, m0, 8192
    s_add_u32 s51, s51, 8192
    v_and_b32 v255, 31, v255
    v_lshl_add_u32 v255, v255, 2, v1
    v_lshlrev_b32 v255, 8, v255
    v_add_u32 v255, 19607552, v255
    buffer_load_dwordx4 v3, s[36:39], s51 offen offset:0 sc1 lds
    s_lshl_b32 s53, s34, 9
    s_add_u32 s54, s53, 83968
    v_lshl_add_u32 v252, v1, 3, s54
    v_xor_b32 v253, 512, v252
    buffer_load_dwordx4 v3, s[36:39], s51 offen offset:1024 sc1 lds
    s_add_u32 m0, m0, 8192
    s_add_u32 s51, s51, 8192
    v_and_b32 v29, 3, v1
    s_lshl_b32 s52, s18, 2
    s_add_u32 s52, s52, 19460096
    v_lshl_add_u32 v29, v29, 7, s52
    buffer_load_dwordx4 v3, s[36:39], s51 offen offset:0 sc1 lds
    v_and_b32 v28, 7, v1
    s_lshl_b32 s50, s18, 5
    s_lshl_b32 s53, s34, 10
    s_add_u32 s50, s50, s53
    buffer_load_dwordx4 v3, s[36:39], s51 offen offset:1024 sc1 lds
    s_add_u32 m0, m0, 8192
    s_add_u32 s51, s51, 8192
    s_add_u32 s50, s50, 19476480
    v_lshl_add_u32 v28, v28, 7, s50
    v_cmp_gt_u32 vcc, 32, v1
    s_nop 1
    v_cndmask_b32 v29, v29, v28, vcc
    buffer_load_dwordx4 v3, s[36:39], s51 offen offset:0 sc1 lds
    v_mov_b32 v244, s48
    v_mov_b32 v245, s48
    s_mov_b32 s24, 0xaaaaaaaa
    s_mov_b32 s25, s24
    buffer_load_dwordx4 v3, s[36:39], s51 offen offset:1024 sc1 lds
    s_add_u32 m0, m0, 8192
    s_add_u32 s51, s51, 8192
    s_mov_b32 s26, 0xcccccccc
    s_mov_b32 s27, s26
    buffer_load_dwordx4 v3, s[36:39], s51 offen offset:0 sc1 lds
    buffer_load_dwordx4 v3, s[36:39], s51 offen offset:1024 sc1 lds
    s_waitcnt vmcnt(10)
    s_barrier
    s_nop 0
    ds_read_b64_tr_b16 v[72:73], v4 offset:0
    ds_read_b64_tr_b16 v[74:75], v4 offset:1024
    ds_read_b64_tr_b16 v[76:77], v4 offset:2048
    ds_read_b64_tr_b16 v[78:79], v4 offset:3072
    ds_read_b64_tr_b16 v[80:81], v5 offset:0
    ds_read_b64_tr_b16 v[82:83], v5 offset:1024
    ds_read_b64_tr_b16 v[84:85], v5 offset:2048
    ds_read_b64_tr_b16 v[86:87], v5 offset:3072
    ds_read_b64_tr_b16 v[88:89], v4 offset:8192
    ds_read_b64_tr_b16 v[90:91], v4 offset:9216
    ds_read_b64_tr_b16 v[92:93], v4 offset:10240
    ds_read_b64_tr_b16 v[94:95], v4 offset:11264
    ds_read_b64_tr_b16 v[96:97], v5 offset:8192
    ds_read_b64_tr_b16 v[98:99], v5 offset:9216
    ds_read_b64_tr_b16 v[100:101], v5 offset:10240
    ds_read_b64_tr_b16 v[102:103], v5 offset:11264
    v_lshrrev_b32 v21, 5, v1
    v_cmp_eq_u32 vcc, s40, v21
    s_nop 1
    v_cndmask_b32 v20, 0, v20, vcc
    v_cvt_pk_bf16_f32 v120, v20, v20
    v_and_b32 v21, 0xffff0000, v120
    v_sub_f32 v21, v20, v21
    v_cvt_pk_bf16_f32 v121, v21, 0
    s_waitcnt lgkmcnt(8)
    v_mfma_f32_4x4x4_16b_bf16 v[48:51], v[244:245], v[72:73], 0
    v_mfma_f32_4x4x4_16b_bf16 v[56:59], v[72:73], v[72:73], 0
    v_mfma_f32_4x4x4_16b_bf16 v[52:55], v[244:245], v[74:75], 0
    v_mfma_f32_4x4x4_16b_bf16 v[60:63], v[74:75], v[74:75], 0
    v_mfma_f32_4x4x4_16b_bf16 v[48:51], v[244:245], v[76:77], v[48:51]
    v_mfma_f32_4x4x4_16b_bf16 v[56:59], v[76:77], v[76:77], v[56:59]
    v_mfma_f32_4x4x4_16b_bf16 v[52:55], v[244:245], v[78:79], v[52:55]
    v_mfma_f32_4x4x4_16b_bf16 v[60:63], v[78:79], v[78:79], v[60:63]
    s_waitcnt lgkmcnt(0)
    v_mfma_f32_4x4x4_16b_bf16 v[48:51], v[244:245], v[88:89], v[48:51]
    v_mfma_f32_4x4x4_16b_bf16 v[56:59], v[88:89], v[88:89], v[56:59]
    v_mfma_f32_4x4x4_16b_bf16 v[52:55], v[244:245], v[90:91], v[52:55]
    v_mfma_f32_4x4x4_16b_bf16 v[60:63], v[90:91], v[90:91], v[60:63]
    v_mfma_f32_4x4x4_16b_bf16 v[48:51], v[244:245], v[92:93], v[48:51]
    v_mfma_f32_4x4x4_16b_bf16 v[56:59], v[92:93], v[92:93], v[56:59]
    v_mfma_f32_4x4x4_16b_bf16 v[52:55], v[244:245], v[94:95], v[52:55]
    v_mfma_f32_4x4x4_16b_bf16 v[60:63], v[94:95], v[94:95], v[60:63]
    v_mfma_f32_32x32x16_bf16 v[32:47], v[128:131], v[72:75], 0
    s_waitcnt vmcnt(6)
    s_barrier
    ds_read_b64_tr_b16 v[104:105], v4 offset:16384
    ds_read_b64_tr_b16 v[106:107], v4 offset:17408
    ds_read_b64_tr_b16 v[108:109], v4 offset:18432
    buffer_load_dword v12, v29, s[36:39], 0 offen sc1
    v_mfma_f32_32x32x16_bf16 v[32:47], v[132:135], v[76:79], v[32:47]
    ds_read_b64_tr_b16 v[110:111], v4 offset:19456
    ds_read_b64_tr_b16 v[112:113], v5 offset:16384
    ds_read_b64_tr_b16 v[114:115], v5 offset:17408
    s_add_u32 s58, s58, 4096
    buffer_load_dwordx4 a[112:115], v2, s[36:39], s58 offen offset:0 sc1
    v_mfma_f32_32x32x16_bf16 v[32:47], v[136:139], v[80:83], v[32:47]
    ds_read_b64_tr_b16 v[116:117], v5 offset:18432
    ds_read_b64_tr_b16 v[118:119], v5 offset:19456
    buffer_load_dwordx4 a[116:119], v2, s[36:39], s58 offen offset:1024 sc1
    v_mfma_f32_32x32x16_bf16 v[32:47], v[140:143], v[84:87], v[32:47]
    buffer_load_dwordx4 a[120:123], v2, s[36:39], s58 offen offset:2048 sc1
    s_waitcnt lgkmcnt(0)
    v_mfma_f32_4x4x4_16b_bf16 v[48:51], v[244:245], v[104:105], v[48:51]
    v_mfma_f32_4x4x4_16b_bf16 v[56:59], v[104:105], v[104:105], v[56:59]
    v_mfma_f32_4x4x4_16b_bf16 v[52:55], v[244:245], v[106:107], v[52:55]
    v_mfma_f32_4x4x4_16b_bf16 v[60:63], v[106:107], v[106:107], v[60:63]
    v_mfma_f32_4x4x4_16b_bf16 v[48:51], v[244:245], v[108:109], v[48:51]
    v_mfma_f32_4x4x4_16b_bf16 v[56:59], v[108:109], v[108:109], v[56:59]
    v_mfma_f32_4x4x4_16b_bf16 v[52:55], v[244:245], v[110:111], v[52:55]
    v_mfma_f32_4x4x4_16b_bf16 v[60:63], v[110:111], v[110:111], v[60:63]
    v_mfma_f32_32x32x16_bf16 v[32:47], v[144:147], v[88:91], v[32:47]
    ds_read_b64_tr_b16 v[72:73], v4 offset:24576
    ds_read_b64_tr_b16 v[74:75], v4 offset:25600
    ds_read_b64_tr_b16 v[76:77], v4 offset:26624
    buffer_load_dwordx4 a[124:127], v2, s[36:39], s58 offen offset:3072 sc1
    v_mfma_f32_32x32x16_bf16 v[32:47], v[148:151], v[92:95], v[32:47]
    ds_read_b64_tr_b16 v[78:79], v4 offset:27648
    ds_read_b64_tr_b16 v[80:81], v5 offset:24576
    ds_read_b64_tr_b16 v[82:83], v5 offset:25600
    s_add_u32 s58, s58, 4096
    buffer_load_dwordx4 a[128:131], v2, s[36:39], s58 offen offset:0 sc1
    v_mfma_f32_32x32x16_bf16 v[32:47], v[152:155], v[96:99], v[32:47]
    ds_read_b64_tr_b16 v[84:85], v5 offset:26624
    ds_read_b64_tr_b16 v[86:87], v5 offset:27648
    buffer_load_dwordx4 a[132:135], v2, s[36:39], s58 offen offset:1024 sc1
    v_mfma_f32_32x32x16_bf16 v[32:47], v[156:159], v[100:103], v[32:47]
    buffer_load_dwordx4 a[136:139], v2, s[36:39], s58 offen offset:2048 sc1
    s_waitcnt lgkmcnt(0)
    v_mfma_f32_4x4x4_16b_bf16 v[48:51], v[244:245], v[72:73], v[48:51]
    v_mfma_f32_4x4x4_16b_bf16 v[56:59], v[72:73], v[72:73], v[56:59]
    v_mfma_f32_4x4x4_16b_bf16 v[52:55], v[244:245], v[74:75], v[52:55]
    v_mfma_f32_4x4x4_16b_bf16 v[60:63], v[74:75], v[74:75], v[60:63]
    v_mfma_f32_4x4x4_16b_bf16 v[48:51], v[244:245], v[76:77], v[48:51]
    v_mfma_f32_4x4x4_16b_bf16 v[56:59], v[76:77], v[76:77], v[56:59]
    v_mfma_f32_4x4x4_16b_bf16 v[52:55], v[244:245], v[78:79], v[52:55]
    v_mfma_f32_4x4x4_16b_bf16 v[60:63], v[78:79], v[78:79], v[60:63]
    v_mfma_f32_32x32x16_bf16 v[32:47], v[160:163], v[104:107], v[32:47]
    s_waitcnt vmcnt(8)
    s_barrier
    ds_read_b64_tr_b16 v[88:89], v4 offset:32768
    ds_read_b64_tr_b16 v[90:91], v4 offset:33792
    ds_read_b64_tr_b16 v[92:93], v4 offset:34816
    buffer_load_dwordx4 a[140:143], v2, s[36:39], s58 offen offset:3072 sc1
    v_mfma_f32_32x32x16_bf16 v[32:47], v[164:167], v[108:111], v[32:47]
    ds_read_b64_tr_b16 v[94:95], v4 offset:35840
    ds_read_b64_tr_b16 v[96:97], v5 offset:32768
    ds_read_b64_tr_b16 v[98:99], v5 offset:33792
    s_add_u32 s58, s58, 4096
    buffer_load_dwordx4 a[144:147], v2, s[36:39], s58 offen offset:0 sc1
    v_mfma_f32_32x32x16_bf16 v[32:47], v[168:171], v[112:115], v[32:47]
    ds_read_b64_tr_b16 v[100:101], v5 offset:34816
    ds_read_b64_tr_b16 v[102:103], v5 offset:35840
    buffer_load_dwordx4 a[148:151], v2, s[36:39], s58 offen offset:1024 sc1
    v_mfma_f32_32x32x16_bf16 v[32:47], v[172:175], v[116:119], v[32:47]
    buffer_load_dwordx4 a[152:155], v2, s[36:39], s58 offen offset:2048 sc1
    s_waitcnt lgkmcnt(0)
    v_mfma_f32_4x4x4_16b_bf16 v[48:51], v[244:245], v[88:89], v[48:51]
    v_mfma_f32_4x4x4_16b_bf16 v[56:59], v[88:89], v[88:89], v[56:59]
    v_mfma_f32_4x4x4_16b_bf16 v[52:55], v[244:245], v[90:91], v[52:55]
    v_mfma_f32_4x4x4_16b_bf16 v[60:63], v[90:91], v[90:91], v[60:63]
    v_mfma_f32_4x4x4_16b_bf16 v[48:51], v[244:245], v[92:93], v[48:51]
    v_mfma_f32_4x4x4_16b_bf16 v[56:59], v[92:93], v[92:93], v[56:59]
    v_mfma_f32_4x4x4_16b_bf16 v[52:55], v[244:245], v[94:95], v[52:55]
    v_mfma_f32_4x4x4_16b_bf16 v[60:63], v[94:95], v[94:95], v[60:63]
    v_mfma_f32_32x32x16_bf16 v[32:47], v[176:179], v[72:75], v[32:47]
    buffer_load_dword v25, off, s[36:39], s14 offset:2048 sc1
    ds_read_b64_tr_b16 v[104:105], v4 offset:40960
    ds_read_b64_tr_b16 v[106:107], v4 offset:41984
    ds_read_b64_tr_b16 v[108:109], v4 offset:43008
    buffer_load_dwordx4 a[156:159], v2, s[36:39], s58 offen offset:3072 sc1
    v_mfma_f32_32x32x16_bf16 v[32:47], v[180:183], v[76:79], v[32:47]
    ds_read_b64_tr_b16 v[110:111], v4 offset:44032
    ds_read_b64_tr_b16 v[112:113], v5 offset:40960
    ds_read_b64_tr_b16 v[114:115], v5 offset:41984
    s_add_u32 s58, s58, 4096
    buffer_load_dwordx4 a[160:163], v2, s[36:39], s58 offen offset:0 sc1
    v_mfma_f32_32x32x16_bf16 v[32:47], v[184:187], v[80:83], v[32:47]
    ds_read_b64_tr_b16 v[116:117], v5 offset:43008
    ds_read_b64_tr_b16 v[118:119], v5 offset:44032
    buffer_load_dwordx4 a[164:167], v2, s[36:39], s58 offen offset:1024 sc1
    v_mfma_f32_32x32x16_bf16 v[32:47], v[188:191], v[84:87], v[32:47]
    buffer_load_dwordx4 a[168:171], v2, s[36:39], s58 offen offset:2048 sc1
    s_waitcnt lgkmcnt(0)
    v_mfma_f32_4x4x4_16b_bf16 v[48:51], v[244:245], v[104:105], v[48:51]
    v_mfma_f32_4x4x4_16b_bf16 v[56:59], v[104:105], v[104:105], v[56:59]
    v_mfma_f32_4x4x4_16b_bf16 v[52:55], v[244:245], v[106:107], v[52:55]
    v_mfma_f32_4x4x4_16b_bf16 v[60:63], v[106:107], v[106:107], v[60:63]
    v_mfma_f32_4x4x4_16b_bf16 v[48:51], v[244:245], v[108:109], v[48:51]
    v_mfma_f32_4x4x4_16b_bf16 v[56:59], v[108:109], v[108:109], v[56:59]
    v_mfma_f32_4x4x4_16b_bf16 v[52:55], v[244:245], v[110:111], v[52:55]
    v_mfma_f32_4x4x4_16b_bf16 v[60:63], v[110:111], v[110:111], v[60:63]
    v_mfma_f32_32x32x16_bf16 v[32:47], v[192:195], v[88:91], v[32:47]
    ds_read_b64_tr_b16 v[72:73], v4 offset:49152
    ds_read_b64_tr_b16 v[74:75], v4 offset:50176
    ds_read_b64_tr_b16 v[76:77], v4 offset:51200
    buffer_load_dwordx4 a[172:175], v2, s[36:39], s58 offen offset:3072 sc1
    v_mfma_f32_32x32x16_bf16 v[32:47], v[196:199], v[92:95], v[32:47]
    ds_read_b64_tr_b16 v[78:79], v4 offset:52224
    ds_read_b64_tr_b16 v[80:81], v5 offset:49152
    ds_read_b64_tr_b16 v[82:83], v5 offset:50176
    s_add_u32 s58, s58, 4096
    buffer_load_dwordx4 a[176:179], v2, s[36:39], s58 offen offset:0 sc1
    v_mfma_f32_32x32x16_bf16 v[32:47], v[200:203], v[96:99], v[32:47]
    ds_read_b64_tr_b16 v[84:85], v5 offset:51200
    ds_read_b64_tr_b16 v[86:87], v5 offset:52224
    buffer_load_dwordx4 a[180:183], v2, s[36:39], s58 offen offset:1024 sc1
    v_mfma_f32_32x32x16_bf16 v[32:47], v[204:207], v[100:103], v[32:47]
    buffer_load_dwordx4 a[184:187], v2, s[36:39], s58 offen offset:2048 sc1
    s_waitcnt lgkmcnt(0)
    v_mfma_f32_4x4x4_16b_bf16 v[48:51], v[244:245], v[72:73], v[48:51]
    v_mfma_f32_4x4x4_16b_bf16 v[56:59], v[72:73], v[72:73], v[56:59]
    v_mfma_f32_4x4x4_16b_bf16 v[52:55], v[244:245], v[74:75], v[52:55]
    v_mfma_f32_4x4x4_16b_bf16 v[60:63], v[74:75], v[74:75], v[60:63]
    v_mfma_f32_4x4x4_16b_bf16 v[48:51], v[244:245], v[76:77], v[48:51]
    v_mfma_f32_4x4x4_16b_bf16 v[56:59], v[76:77], v[76:77], v[56:59]
    v_mfma_f32_4x4x4_16b_bf16 v[52:55], v[244:245], v[78:79], v[52:55]
    v_mfma_f32_4x4x4_16b_bf16 v[60:63], v[78:79], v[78:79], v[60:63]
    v_mfma_f32_32x32x16_bf16 v[32:47], v[208:211], v[104:107], v[32:47]
    s_nop 2
    v_add_f32 v30, v48, v52
    buffer_load_dwordx4 a[188:191], v2, s[36:39], s58 offen offset:3072 sc1
    v_mfma_f32_32x32x16_bf16 v[32:47], v[212:215], v[108:111], v[32:47]
    v_add_f32 v56, v56, v60
    v_add_f32 v57, v57, v61
    v_add_f32 v58, v58, v62
    v_add_f32 v59, v59, v63
    v_cndmask_b32 v56, v56, v57, s[24:25]
    v_cndmask_b32 v58, v58, v59, s[24:25]
    v_cndmask_b32 v31, v56, v58, s[26:27]
    ds_write_b64 v252, v[30:31]
    v_mfma_f32_32x32x16_bf16 v[32:47], v[216:219], v[112:115], v[32:47]
    s_add_u32 s58, s58, 4096
    buffer_load_dwordx4 a[192:195], v2, s[36:39], s58 offen offset:0 sc1
    v_mfma_f32_32x32x16_bf16 v[32:47], v[220:223], v[116:119], v[32:47]
    s_waitcnt lgkmcnt(0)
    s_barrier
    ds_read_b64 v[26:27], v253
    buffer_load_dwordx4 a[196:199], v2, s[36:39], s58 offen offset:1024 sc1
    v_mfma_f32_32x32x16_bf16 v[32:47], v[224:227], v[72:75], v[32:47]
    ds_read_b64_tr_b16 v[64:65], v251 offset:0
    ds_read_b64_tr_b16 v[66:67], v251 offset:1024
    ds_read_b64_tr_b16 v[68:69], v251 offset:2048
    ds_read_b64_tr_b16 v[70:71], v251 offset:3072
    v_mfma_f32_32x32x16_bf16 v[32:47], v[228:231], v[76:79], v[32:47]
    s_waitcnt lgkmcnt(4)
    v_add_f32 v30, v30, v26
    v_add_f32 v31, v31, v27
    v_mov_b32 v26, v30
    v_mov_b32 v27, v31
    v_mfma_f32_32x32x16_bf16 v[32:47], v[232:235], v[80:83], v[32:47]
    v_permlane32_swap_b32 v30, v26
    v_permlane32_swap_b32 v31, v27
    v_add_f32 v30, v30, v26
    v_add_f32 v31, v31, v27
    v_mul_f32 v20, 0xbb124925, v30
    v_cvt_pk_bf16_f32 v241, v20, 0
    v_mfma_f32_32x32x16_bf16 v[32:47], v[236:239], v[84:87], v[32:47]
    v_lshlrev_b32 v26, 16, v241
    v_sub_f32 v26, v20, v26
    v_cvt_pk_bf16_f32 v240, v20, v26
    v_mul_f32 v23, 0x3b124925, v31
    v_fma_f32 v23, -v20, v20, v23
    v_max_f32 v23, 0, v23
    v_mfma_f32_32x32x16_bf16 v[32:47], v[120:123], v[240:243], v[32:47]
    v_add_f32 v26, 0x3727c5ac, v23
    v_rsq_f32 v21, v26
    v_mov_b32 v26, 0x3727c5ac
    v_mul_f32 v23, v23, v21
    v_fmac_f32 v26, v23, v21
    v_rsq_f32 v22, v26
    v_mov_b32 v23, 0x3d372713
    v_mul_f32 v22, v22, v21
    v_mul_f32 v248, 0xc0135761, v22
    v_mul_f32 v23, v23, v22
    v_mul_f32 v249, v248, v22
    v_rcp_f32 v22, v22
    v_mul_f32_e64 v249, v249, v23
    v_pk_mul_f32 v[96:97], v[32:33], v[32:33]
    v_pk_mul_f32 v[98:99], v[34:35], v[34:35]
    v_pk_mul_f32 v[100:101], v[36:37], v[36:37]
    v_pk_mul_f32 v[102:103], v[38:39], v[38:39]
    v_pk_fma_f32 v[96:97], v[96:97], v[248:249], v[248:249] op_sel:[0,1,0] op_sel_hi:[1,1,0]
    v_pk_fma_f32 v[98:99], v[98:99], v[248:249], v[248:249] op_sel:[0,1,0] op_sel_hi:[1,1,0]
    v_pk_fma_f32 v[100:101], v[100:101], v[248:249], v[248:249] op_sel:[0,1,0] op_sel_hi:[1,1,0]
    v_pk_fma_f32 v[102:103], v[102:103], v[248:249], v[248:249] op_sel:[0,1,0] op_sel_hi:[1,1,0]
    v_pk_mul_f32 v[96:97], v[96:97], v[32:33]
    v_pk_mul_f32 v[98:99], v[98:99], v[34:35]
    v_pk_mul_f32 v[100:101], v[100:101], v[36:37]
    v_pk_mul_f32 v[102:103], v[102:103], v[38:39]
    v_exp_f32 v96, v96
    v_exp_f32 v97, v97
    v_exp_f32 v98, v98
    v_exp_f32 v99, v99
    v_exp_f32 v100, v100
    v_exp_f32 v101, v101
    v_exp_f32 v102, v102
    v_exp_f32 v103, v103
    v_pk_fma_f32 v[96:97], v[96:97], v[22:23], v[22:23] op_sel_hi:[1,0,0]
    v_pk_fma_f32 v[98:99], v[98:99], v[22:23], v[22:23] op_sel_hi:[1,0,0]
    v_pk_fma_f32 v[100:101], v[100:101], v[22:23], v[22:23] op_sel_hi:[1,0,0]
    v_pk_fma_f32 v[102:103], v[102:103], v[22:23], v[22:23] op_sel_hi:[1,0,0]
    v_rcp_f32 v96, v96
    v_rcp_f32 v97, v97
    v_rcp_f32 v98, v98
    v_rcp_f32 v99, v99
    v_rcp_f32 v100, v100
    v_rcp_f32 v101, v101
    v_rcp_f32 v102, v102
    v_rcp_f32 v103, v103
    v_pk_mul_f32 v[96:97], v[96:97], v[32:33]
    v_pk_mul_f32 v[98:99], v[98:99], v[34:35]
    v_pk_mul_f32 v[100:101], v[100:101], v[36:37]
    v_pk_mul_f32 v[102:103], v[102:103], v[38:39]
    v_cvt_pk_bf16_f32 v88, v96, v97
    v_cvt_pk_bf16_f32 v89, v98, v99
    v_cvt_pk_bf16_f32 v90, v100, v101
    v_cvt_pk_bf16_f32 v91, v102, v103
    buffer_store_dwordx4 v[88:91], v6, s[36:39], s12 offen offset:0 sc1
    v_pk_mul_f32 v[104:105], v[40:41], v[40:41]
    v_pk_mul_f32 v[106:107], v[42:43], v[42:43]
    v_pk_mul_f32 v[108:109], v[44:45], v[44:45]
    v_pk_mul_f32 v[110:111], v[46:47], v[46:47]
    v_pk_fma_f32 v[104:105], v[104:105], v[248:249], v[248:249] op_sel:[0,1,0] op_sel_hi:[1,1,0]
    v_pk_fma_f32 v[106:107], v[106:107], v[248:249], v[248:249] op_sel:[0,1,0] op_sel_hi:[1,1,0]
    v_pk_fma_f32 v[108:109], v[108:109], v[248:249], v[248:249] op_sel:[0,1,0] op_sel_hi:[1,1,0]
    v_pk_fma_f32 v[110:111], v[110:111], v[248:249], v[248:249] op_sel:[0,1,0] op_sel_hi:[1,1,0]
    v_pk_mul_f32 v[104:105], v[104:105], v[40:41]
    v_pk_mul_f32 v[106:107], v[106:107], v[42:43]
    v_pk_mul_f32 v[108:109], v[108:109], v[44:45]
    v_pk_mul_f32 v[110:111], v[110:111], v[46:47]
    v_exp_f32 v104, v104
    v_exp_f32 v105, v105
    v_exp_f32 v106, v106
    v_exp_f32 v107, v107
    v_exp_f32 v108, v108
    v_exp_f32 v109, v109
    v_exp_f32 v110, v110
    v_exp_f32 v111, v111
    v_pk_fma_f32 v[104:105], v[104:105], v[22:23], v[22:23] op_sel_hi:[1,0,0]
    v_pk_fma_f32 v[106:107], v[106:107], v[22:23], v[22:23] op_sel_hi:[1,0,0]
    v_pk_fma_f32 v[108:109], v[108:109], v[22:23], v[22:23] op_sel_hi:[1,0,0]
    v_pk_fma_f32 v[110:111], v[110:111], v[22:23], v[22:23] op_sel_hi:[1,0,0]
    v_rcp_f32 v104, v104
    v_rcp_f32 v105, v105
    v_rcp_f32 v106, v106
    v_rcp_f32 v107, v107
    v_rcp_f32 v108, v108
    v_rcp_f32 v109, v109
    v_rcp_f32 v110, v110
    v_rcp_f32 v111, v111
    v_pk_mul_f32 v[104:105], v[104:105], v[40:41]
    v_pk_mul_f32 v[106:107], v[106:107], v[42:43]
    v_pk_mul_f32 v[108:109], v[108:109], v[44:45]
    v_pk_mul_f32 v[110:111], v[110:111], v[46:47]
    v_cvt_pk_bf16_f32 v92, v104, v105
    v_cvt_pk_bf16_f32 v93, v106, v107
    v_cvt_pk_bf16_f32 v94, v108, v109
    v_cvt_pk_bf16_f32 v95, v110, v111
    buffer_store_dwordx4 v[92:95], v6, s[36:39], s12 offen offset:2048 sc1
    s_waitcnt vmcnt(13)
    v_cmp_gt_u32 vcc, 4, v25
    s_cbranch_vccnz K_W4s
K_W4r:
    s_waitcnt lgkmcnt(0)
    ds_write_b128 v124, a[200:203] offset:0
    v_lshlrev_b32 v72, 16, v64
    v_and_b32 v73, 0xffff0000, v64
    ds_write_b128 v124, a[204:207] offset:128
    buffer_load_dwordx4 v[128:131], v8, s[36:39], s4 offen offset:0 sc1
    v_lshlrev_b32 v74, 16, v65
    v_and_b32 v75, 0xffff0000, v65
    ds_write_b128 v125, a[208:211] offset:256
    buffer_load_dwordx4 v[132:135], v8, s[36:39], s4 offen offset:1024 sc1
    v_lshlrev_b32 v76, 16, v66
    v_and_b32 v77, 0xffff0000, v66
    ds_write_b128 v125, a[212:215] offset:384
    buffer_load_dwordx4 v[136:139], v8, s[36:39], s4 offen offset:2048 sc1
    v_lshlrev_b32 v78, 16, v67
    v_and_b32 v79, 0xffff0000, v67
    ds_write_b128 v124, a[216:219] offset:512
    buffer_load_dwordx4 v[140:143], v8, s[36:39], s4 offen offset:3072 sc1
    v_lshlrev_b32 v80, 16, v68
    v_and_b32 v81, 0xffff0000, v68
    ds_write_b128 v124, a[220:223] offset:640
    buffer_load_dwordx4 v[144:147], v8, s[36:39], s5 offen offset:0 sc1
    v_lshlrev_b32 v82, 16, v69
    v_and_b32 v83, 0xffff0000, v69
    ds_write_b128 v125, a[224:227] offset:768
    v_lshlrev_b32 v84, 16, v70
    v_and_b32 v85, 0xffff0000, v70
    ds_write_b128 v125, a[228:231] offset:896
    v_lshlrev_b32 v86, 16, v71
    v_and_b32 v87, 0xffff0000, v71
    ds_write_b128 v124, a[232:235] offset:1024
    v_mul_f32_e64 v20, v20, v21
    v_pk_fma_f32 v[48:49], v[72:73], v[20:21], v[20:21] op_sel:[0,1,0] op_sel_hi:[1,1,0]
    ds_write_b128 v124, a[236:239] offset:1152
    v_pk_fma_f32 v[50:51], v[74:75], v[20:21], v[20:21] op_sel:[0,1,0] op_sel_hi:[1,1,0]
    v_pk_fma_f32 v[52:53], v[76:77], v[20:21], v[20:21] op_sel:[0,1,0] op_sel_hi:[1,1,0]
    ds_write_b128 v125, a[240:243] offset:1280
    v_pk_fma_f32 v[54:55], v[78:79], v[20:21], v[20:21] op_sel:[0,1,0] op_sel_hi:[1,1,0]
    v_pk_fma_f32 v[56:57], v[80:81], v[20:21], v[20:21] op_sel:[0,1,0] op_sel_hi:[1,1,0]
    ds_write_b128 v125, a[244:247] offset:1408
    v_pk_fma_f32 v[58:59], v[82:83], v[20:21], v[20:21] op_sel:[0,1,0] op_sel_hi:[1,1,0]
    v_pk_fma_f32 v[60:61], v[84:85], v[20:21], v[20:21] op_sel:[0,1,0] op_sel_hi:[1,1,0]
    ds_write_b128 v124, a[248:251] offset:1536
    v_pk_fma_f32 v[62:63], v[86:87], v[20:21], v[20:21] op_sel:[0,1,0] op_sel_hi:[1,1,0]
    s_mul_i32 s51, s34, 14336
    ds_write_b128 v124, a[252:255] offset:1664
    s_mov_b32 m0, s51
    v_mov_b32 v28, 1
    v_lshlrev_b32 v29, 6, v1
    s_add_u32 s52, s19, s45
    s_add_u32 s55, s52, 196608
    s_waitcnt vmcnt(5)
    s_barrier
    s_mov_b64 exec, 7
    buffer_atomic_add v28, v255, s[36:39], s45 offen sc1
    s_mov_b64 exec, -1
    s_waitcnt lgkmcnt(0)
    buffer_load_dwordx4 v[148:151], v8, s[36:39], s5 offen offset:1024 sc1
    buffer_load_dwordx4 v[152:155], v8, s[36:39], s5 offen offset:2048 sc1
    buffer_load_dwordx4 v[156:159], v8, s[36:39], s5 offen offset:3072 sc1
    buffer_load_dwordx4 v[160:163], v8, s[36:39], s6 offen offset:0 sc1
    buffer_load_dwordx4 v[164:167], v8, s[36:39], s6 offen offset:1024 sc1
    buffer_load_dwordx4 v[168:171], v8, s[36:39], s6 offen offset:2048 sc1
    buffer_load_dwordx4 v[172:175], v8, s[36:39], s6 offen offset:3072 sc1
    v_mov_b32 v12, 0
    s_mov_b64 exec, 7
    buffer_atomic_add v12, v15, s[36:39], s45 offen sc0 sc1
    s_mov_b64 exec, -1
    s_cmp_lg_u32 s34, 0
    s_cbranch_scc1 K_AS_2e
K_PGB0:
    s_cbranch_execz K_WRB
    s_nop 0
    s_mov_b32 s54, 1048576
    s_mov_b64 exec, 7
    s_waitcnt vmcnt(0)
    v_cmp_gt_u32 vcc, 7, v12
    s_cbranch_vccz K_AS_2x
K_AS_2:
    v_mov_b32 v12, 0
    buffer_atomic_add v12, v15, s[36:39], 0 offen sc0 sc1
    s_sub_u32 s54, s54, 1
    s_cselect_b32 s55, 0, 7
    s_waitcnt vmcnt(0)
    v_cmp_gt_u32 vcc, s55, v12
    s_cbranch_vccz K_AS_2x
    v_mov_b32 v12, 0
    buffer_atomic_add v12, v15, s[36:39], 0 offen sc0 sc1
    s_sub_u32 s54, s54, 1
    s_cselect_b32 s55, 0, 7
    s_waitcnt vmcnt(0)
    v_cmp_gt_u32 vcc, s55, v12
    s_cbranch_vccz K_AS_2x
    s_branch K_AS_2
K_AS_2x:
    s_mov_b64 exec, -1
K_AS_2e:
    s_barrier
    buffer_load_dwordx4 v13, s[36:39], s51 offen offset:0 sc1 lds
    buffer_load_dwordx4 v14, s[36:39], s51 offen offset:1024 sc1 lds
    buffer_load_dwordx4 v13, s[36:39], s51 offen offset:2048 sc1 lds
    buffer_load_dwordx4 v14, s[36:39], s51 offen offset:3072 sc1 lds
    s_add_u32 m0, m0, 4096
    s_add_u32 s51, s51, 4096
    buffer_load_dwordx4 v13, s[36:39], s51 offen offset:0 sc1 lds
    buffer_load_dwordx4 v14, s[36:39], s51 offen offset:1024 sc1 lds
    buffer_load_dwordx4 v13, s[36:39], s51 offen offset:2048 sc1 lds
    buffer_load_dwordx4 v14, s[36:39], s51 offen offset:3072 sc1 lds
    s_add_u32 m0, m0, 4096
    s_add_u32 s51, s51, 4096
    buffer_load_dwordx4 v13, s[36:39], s51 offen offset:0 sc1 lds
    buffer_load_dwordx4 v14, s[36:39], s51 offen offset:1024 sc1 lds
    s_lshl_b32 s59, s18, 2
    s_add_u32 s59, s59, 19460096
    v_add_u32 v15, s59, v7
    s_lshl_b32 s19, s43, 2
    s_add_u32 s19, s19, s59
    s_nop 0
    ds_read_b64_tr_b16 v[88:89], v250 offset:0
    ds_read_b64_tr_b16 v[90:91], v250 offset:1024
    ds_read_b64_tr_b16 v[92:93], v250 offset:14336
    ds_read_b64_tr_b16 v[94:95], v250 offset:15360
    ds_read_b64_tr_b16 v[96:97], v250 offset:28672
    ds_read_b64_tr_b16 v[98:99], v250 offset:29696
    ds_read_b64_tr_b16 v[100:101], v250 offset:43008
    ds_read_b64_tr_b16 v[102:103], v250 offset:44032
    ds_read_b64_tr_b16 v[104:105], v250 offset:2048
    ds_read_b64_tr_b16 v[106:107], v250 offset:3072
    ds_read_b64_tr_b16 v[108:109], v250 offset:16384
    ds_read_b64_tr_b16 v[110:111], v250 offset:17408
    s_waitcnt vmcnt(8)
    s_barrier
    ds_read_b128 v[32:35], v6 offset:0
    ds_read_b128 v[36:39], v6 offset:14336
    ds_read_b128 v[40:43], v6 offset:28672
    ds_read_b128 v[44:47], v6 offset:43008
    buffer_load_dwordx4 v13, s[36:39], s51 offen offset:2048 sc1 lds
    buffer_load_dwordx4 v14, s[36:39], s51 offen offset:3072 sc1 lds
    s_add_u32 m0, m0, 4096
    s_add_u32 s51, s51, 4096
    s_waitcnt lgkmcnt(2)
    v_mfma_f32_32x32x16_bf16 v[48:63], v[88:91], v[32:35], v[48:63]
    ds_read_b64_tr_b16 v[112:113], v250 offset:30720
    ds_read_b64_tr_b16 v[114:115], v250 offset:31744
    s_waitcnt vmcnt(8)
    s_barrier
    ds_read_b128 v[64:67], v6 offset:2048
    v_mfma_f32_32x32x16_bf16 v[48:63], v[92:95], v[36:39], v[48:63]
    ds_read_b64_tr_b16 v[116:117], v250 offset:45056
    ds_read_b64_tr_b16 v[118:119], v250 offset:46080
    ds_read_b128 v[68:71], v6 offset:16384
    buffer_load_dwordx4 v13, s[36:39], s51 offen offset:0 sc1 lds
    s_waitcnt lgkmcnt(6)
    v_mfma_f32_32x32x16_bf16 v[48:63], v[96:99], v[40:43], v[48:63]
    ds_read_b64_tr_b16 v[88:89], v250 offset:4096
    ds_read_b64_tr_b16 v[90:91], v250 offset:5120
    ds_read_b128 v[32:35], v6 offset:30720
    v_mfma_f32_32x32x16_bf16 v[48:63], v[100:103], v[44:47], v[48:63]
    ds_read_b64_tr_b16 v[92:93], v250 offset:18432
    ds_read_b64_tr_b16 v[94:95], v250 offset:19456
    ds_read_b128 v[36:39], v6 offset:45056
    buffer_load_dwordx4 v14, s[36:39], s51 offen offset:1024 sc1 lds
    s_waitcnt lgkmcnt(6)
    v_mfma_f32_32x32x16_bf16 v[48:63], v[104:107], v[64:67], v[48:63]
    ds_read_b64_tr_b16 v[96:97], v250 offset:32768
    ds_read_b64_tr_b16 v[98:99], v250 offset:33792
    s_waitcnt vmcnt(8)
    s_barrier
    ds_read_b128 v[40:43], v6 offset:4096
    v_mfma_f32_32x32x16_bf16 v[48:63], v[108:111], v[68:71], v[48:63]
    ds_read_b64_tr_b16 v[100:101], v250 offset:47104
    ds_read_b64_tr_b16 v[102:103], v250 offset:48128
    ds_read_b128 v[44:47], v6 offset:18432
    s_waitcnt lgkmcnt(6)
    v_mfma_f32_32x32x16_bf16 v[48:63], v[112:115], v[32:35], v[48:63]
    ds_read_b64_tr_b16 v[104:105], v250 offset:6144
    ds_read_b64_tr_b16 v[106:107], v250 offset:7168
    ds_read_b128 v[64:67], v6 offset:32768
    v_mfma_f32_32x32x16_bf16 v[48:63], v[116:119], v[36:39], v[48:63]
    ds_read_b64_tr_b16 v[108:109], v250 offset:20480
    ds_read_b64_tr_b16 v[110:111], v250 offset:21504
    ds_read_b128 v[68:71], v6 offset:47104
    s_waitcnt lgkmcnt(6)
    v_mfma_f32_32x32x16_bf16 v[48:63], v[88:91], v[40:43], v[48:63]
    ds_read_b64_tr_b16 v[112:113], v250 offset:34816
    ds_read_b64_tr_b16 v[114:115], v250 offset:35840
    s_waitcnt vmcnt(6)
    s_barrier
    ds_read_b128 v[32:35], v6 offset:6144
    v_mfma_f32_32x32x16_bf16 v[48:63], v[92:95], v[44:47], v[48:63]
    ds_read_b64_tr_b16 v[116:117], v250 offset:49152
    ds_read_b64_tr_b16 v[118:119], v250 offset:50176
    ds_read_b128 v[36:39], v6 offset:20480
    s_waitcnt lgkmcnt(6)
    v_mfma_f32_32x32x16_bf16 v[48:63], v[96:99], v[64:67], v[48:63]
    ds_read_b64_tr_b16 v[88:89], v250 offset:8192
    ds_read_b64_tr_b16 v[90:91], v250 offset:9216
    ds_read_b128 v[40:43], v6 offset:34816
    v_mfma_f32_32x32x16_bf16 v[48:63], v[100:103], v[68:71], v[48:63]
    ds_read_b64_tr_b16 v[92:93], v250 offset:22528
    ds_read_b64_tr_b16 v[94:95], v250 offset:23552
    ds_read_b128 v[44:47], v6 offset:49152
    s_waitcnt lgkmcnt(6)
    v_mfma_f32_32x32x16_bf16 v[48:63], v[104:107], v[32:35], v[48:63]
    ds_read_b64_tr_b16 v[96:97], v250 offset:36864
    ds_read_b64_tr_b16 v[98:99], v250 offset:37888
    s_waitcnt vmcnt(4)
    s_barrier
    ds_read_b128 v[64:67], v6 offset:8192
    v_mfma_f32_32x32x16_bf16 v[48:63], v[108:111], v[36:39], v[48:63]
    ds_read_b64_tr_b16 v[100:101], v250 offset:51200
    ds_read_b64_tr_b16 v[102:103], v250 offset:52224
    ds_read_b128 v[68:71], v6 offset:22528
    buffer_load_dwordx4 v[176:179], v8, s[36:39], s7 offen offset:0 sc1
    s_waitcnt lgkmcnt(6)
    v_mfma_f32_32x32x16_bf16 v[48:63], v[112:115], v[40:43], v[48:63]
    ds_read_b64_tr_b16 v[104:105], v250 offset:10240
    ds_read_b64_tr_b16 v[106:107], v250 offset:11264
    ds_read_b128 v[32:35], v6 offset:36864
    v_mfma_f32_32x32x16_bf16 v[48:63], v[116:119], v[44:47], v[48:63]
    ds_read_b64_tr_b16 v[108:109], v250 offset:24576
    ds_read_b64_tr_b16 v[110:111], v250 offset:25600
    ds_read_b128 v[36:39], v6 offset:51200
    buffer_load_dwordx4 v[180:183], v8, s[36:39], s7 offen offset:1024 sc1
    s_waitcnt lgkmcnt(6)
    v_mfma_f32_32x32x16_bf16 v[48:63], v[88:91], v[64:67], v[48:63]
    ds_read_b64_tr_b16 v[112:113], v250 offset:38912
    ds_read_b64_tr_b16 v[114:115], v250 offset:39936
    s_waitcnt vmcnt(4)
    s_barrier
    ds_read_b128 v[40:43], v6 offset:10240
    v_mfma_f32_32x32x16_bf16 v[48:63], v[92:95], v[68:71], v[48:63]
    ds_read_b64_tr_b16 v[116:117], v250 offset:53248
    ds_read_b64_tr_b16 v[118:119], v250 offset:54272
    ds_read_b128 v[44:47], v6 offset:24576
    buffer_load_dwordx4 v[184:187], v8, s[36:39], s7 offen offset:2048 sc1
    s_waitcnt lgkmcnt(6)
    v_mfma_f32_32x32x16_bf16 v[48:63], v[96:99], v[32:35], v[48:63]
    ds_read_b64_tr_b16 v[88:89], v250 offset:12288
    ds_read_b64_tr_b16 v[90:91], v250 offset:13312
    ds_read_b128 v[64:67], v6 offset:38912
    v_mfma_f32_32x32x16_bf16 v[48:63], v[100:103], v[36:39], v[48:63]
    ds_read_b64_tr_b16 v[92:93], v250 offset:26624
    ds_read_b64_tr_b16 v[94:95], v250 offset:27648
    ds_read_b128 v[68:71], v6 offset:53248
    buffer_load_dwordx4 v[188:191], v8, s[36:39], s7 offen offset:3072 sc1
    s_waitcnt lgkmcnt(6)
    v_mfma_f32_32x32x16_bf16 v[48:63], v[104:107], v[40:43], v[48:63]
    ds_read_b64_tr_b16 v[96:97], v250 offset:40960
    ds_read_b64_tr_b16 v[98:99], v250 offset:41984
    s_waitcnt vmcnt(4)
    s_barrier
    ds_read_b128 v[32:35], v6 offset:12288
    v_mfma_f32_32x32x16_bf16 v[48:63], v[108:111], v[44:47], v[48:63]
    ds_read_b64_tr_b16 v[100:101], v250 offset:55296
    ds_read_b64_tr_b16 v[102:103], v250 offset:56320
    ds_read_b128 v[36:39], v6 offset:26624
    buffer_load_dwordx4 v[192:195], v8, s[36:39], s8 offen offset:0 sc1
    s_waitcnt lgkmcnt(6)
    v_mfma_f32_32x32x16_bf16 v[48:63], v[112:115], v[64:67], v[48:63]
    ds_read_b128 v[40:43], v6 offset:40960
    v_mfma_f32_32x32x16_bf16 v[48:63], v[116:119], v[68:71], v[48:63]
    ds_read_b128 v[44:47], v6 offset:55296
    buffer_load_dwordx4 v[196:199], v8, s[36:39], s8 offen offset:1024 sc1
    s_waitcnt lgkmcnt(2)
    v_mfma_f32_32x32x16_bf16 v[48:63], v[88:91], v[32:35], v[48:63]
    v_mfma_f32_32x32x16_bf16 v[48:63], v[92:95], v[36:39], v[48:63]
    buffer_load_dwordx4 v[200:203], v8, s[36:39], s8 offen offset:2048 sc1
    s_waitcnt lgkmcnt(0)
    v_mfma_f32_32x32x16_bf16 v[48:63], v[96:99], v[40:43], v[48:63]
    v_mfma_f32_32x32x16_bf16 v[48:63], v[100:103], v[44:47], v[48:63]
    buffer_load_dwordx4 v[204:207], v8, s[36:39], s8 offen offset:3072 sc1
    s_nop 10
    v_cvt_pk_bf16_f32 v88, v48, v49
    v_cvt_pk_bf16_f32 v89, v50, v51
    v_cvt_pk_bf16_f32 v90, v52, v53
    v_cvt_pk_bf16_f32 v91, v54, v55
    buffer_store_dwordx4 v[88:91], v17, s[36:39], 0 offen offset:0 sc1
    v_cvt_pk_bf16_f32 v92, v56, v57
    v_cvt_pk_bf16_f32 v93, v58, v59
    v_cvt_pk_bf16_f32 v94, v60, v61
    v_cvt_pk_bf16_f32 v95, v62, v63
    buffer_store_dwordx4 v[92:95], v17, s[36:39], 0 offen offset:1024 sc1
    s_nop 0
    v_dot2_f32_bf16 v30, v88, s48, 0
    v_dot2_f32_bf16 v31, v88, v88, 0
    v_dot2_f32_bf16 v30, v89, s48, v30
    v_dot2_f32_bf16 v31, v89, v89, v31
    v_dot2_f32_bf16 v30, v90, s48, v30
    v_dot2_f32_bf16 v31, v90, v90, v31
    v_dot2_f32_bf16 v30, v91, s48, v30
    v_dot2_f32_bf16 v31, v91, v91, v31
    v_dot2_f32_bf16 v30, v92, s48, v30
    v_dot2_f32_bf16 v31, v92, v92, v31
    v_dot2_f32_bf16 v30, v93, s48, v30
    v_dot2_f32_bf16 v31, v93, v93, v31
    v_dot2_f32_bf16 v30, v94, s48, v30
    v_dot2_f32_bf16 v31, v94, v94, v31
    v_dot2_f32_bf16 v30, v95, s48, v30
    v_dot2_f32_bf16 v31, v95, v95, v31
    s_nop 2
    v_permlane32_swap_b32 v30, v31
    v_add_f32 v30, v30, v31
    buffer_store_dword v30, v18, s[36:39], 0 offen sc1
    buffer_load_dwordx4 v[208:211], v8, s[36:39], s9 offen offset:0 sc1
    s_nop 0
    v_pk_add_f32 v[72:73], v[72:73], v[48:49]
    v_pk_add_f32 v[74:75], v[74:75], v[50:51]
    v_pk_add_f32 v[76:77], v[76:77], v[52:53]
    v_pk_add_f32 v[78:79], v[78:79], v[54:55]
    v_pk_add_f32 v[80:81], v[80:81], v[56:57]
    v_pk_add_f32 v[82:83], v[82:83], v[58:59]
    v_pk_add_f32 v[84:85], v[84:85], v[60:61]
    v_pk_add_f32 v[86:87], v[86:87], v[62:63]
    ds_write_b128 v19, v[72:75] offset:0
    ds_write_b128 v19, v[76:79] offset:1088
    ds_write_b128 v19, v[80:83] offset:2176
    ds_write_b128 v19, v[84:87] offset:3264
    v_mov_b32 v28, 1
    v_lshlrev_b32 v29, 6, v1
    s_add_u32 s52, s19, s45
    s_add_u32 s55, s52, 196608
    s_waitcnt vmcnt(1)
    s_barrier
    s_mov_b64 exec, 0xff
    buffer_store_dword v28, v29, s[36:39], s52 offen
    s_mov_b64 exec, -1
    v_cvt_pk_bf16_f32 v97, v24, v24
    v_and_b32 v98, 0xffff0000, v97
    v_sub_f32 v98, v24, v98
    v_cvt_pk_bf16_f32 v98, v98, 0
    v_cmp_gt_u32 vcc, 32, v1
    v_mov_b32 v126, 0
    v_mov_b32 v127, 0
    v_cndmask_b32 v120, 0, v97, vcc
    v_cndmask_b32 v121, 0, v98, vcc
    v_cndmask_b32 v124, v97, v126, vcc
    v_cndmask_b32 v125, v98, v126, vcc
    v_mov_b32 v246, 0
    v_mov_b32 v247, 0
    s_lshl_b32 s51, s42, 16
    s_lshl_b32 s53, s34, 11
    s_add_u32 s51, s51, s53
    s_add_u32 s51, s51, 4718592
    s_mov_b32 m0, s53
    s_cmp_eq_u32 s34, 3
    s_cselect_b32 s53, 2130706432, 0
    v_add_u32 v13, s53, v2
    s_add_u32 s54, s59, 512
    s_add_u32 s56, s19, 196608
K_X2l:
    s_cmp_eq_u32 s59, s54
    s_cbranch_scc1 K_X2s
    s_load_dwordx8 s[20:27], s[32:33], s59
    s_add_u32 s59, s59, 64
    s_waitcnt lgkmcnt(0)
    s_and_b64 s[20:21], s[20:21], s[22:23]
    s_and_b64 s[20:21], s[20:21], s[24:25]
    s_and_b32 s20, s20, s21
    s_and_b32 s20, s20, s26
    s_cbranch_scc0 K_X2l
K_X2r:
    buffer_load_dwordx4 v2, s[36:39], s51 offen offset:0 sc1 lds
    buffer_load_dwordx4 v2, s[36:39], s51 offen offset:1024 sc1 lds
    s_add_u32 m0, m0, 8192
    s_add_u32 s51, s51, 8192
    buffer_load_dwordx4 v2, s[36:39], s51 offen offset:0 sc1 lds
    buffer_load_dwordx4 v2, s[36:39], s51 offen offset:1024 sc1 lds
    s_add_u32 m0, m0, 8192
    s_add_u32 s51, s51, 8192
    buffer_load_dwordx4 v2, s[36:39], s51 offen offset:0 sc1 lds
    buffer_load_dwordx4 v2, s[36:39], s51 offen offset:1024 sc1 lds
    s_add_u32 m0, m0, 8192
    s_add_u32 s51, s51, 8192
    buffer_load_dwordx4 v2, s[36:39], s51 offen offset:0 sc1 lds
    buffer_load_dwordx4 v2, s[36:39], s51 offen offset:1024 sc1 lds
    s_add_u32 m0, m0, 8192
    s_add_u32 s51, s51, 8192
    buffer_load_dwordx4 v2, s[36:39], s51 offen offset:0 sc1 lds
    buffer_load_dwordx4 v2, s[36:39], s51 offen offset:1024 sc1 lds
    s_add_u32 m0, m0, 8192
    s_add_u32 s51, s51, 8192
    buffer_load_dwordx4 v2, s[36:39], s51 offen offset:0 sc1 lds
    buffer_load_dwordx4 v2, s[36:39], s51 offen offset:1024 sc1 lds
    s_add_u32 m0, m0, 8192
    s_add_u32 s51, s51, 8192
    v_add_u32 v15, s50, v7
    s_lshl_b32 s19, s43, 2
    s_add_u32 s19, s19, s50
    s_add_u32 s59, s19, 196608
    v_lshlrev_b32 v18, 3, v1
    s_waitcnt vmcnt(63)
    s_waitcnt vmcnt(10)
    s_barrier
    ds_read_b128 v[96:99], v2 offset:0
    ds_read_b128 v[100:103], v2 offset:1024
    ds_read_b128 v[104:107], v2 offset:2048
    ds_read_b128 v[108:111], v2 offset:3072
    ds_read_b128 v[112:115], v2 offset:4096
    ds_read_b128 v[116:119], v2 offset:5120
    ds_read_b128 a[224:227], v2 offset:6144
    buffer_load_dwordx4 v2, s[36:39], s51 offen offset:0 sc1 lds
    buffer_load_dwordx4 v2, s[36:39], s51 offen offset:1024 sc1 lds
    s_add_u32 m0, m0, 8192
    s_add_u32 s51, s51, 8192
    s_waitcnt lgkmcnt(3)
    v_mfma_f32_32x32x16_bf16 v[32:47], a[0:3], v[96:99], 0
    buffer_load_dwordx4 v2, s[36:39], s51 offen offset:0 sc1 lds
    ds_read_b128 a[228:231], v2 offset:7168
    v_mfma_f32_32x32x16_bf16 v[32:47], a[4:7], v[100:103], v[32:47]
    s_waitcnt vmcnt(11)
    s_barrier
    ds_read_b128 a[232:235], v2 offset:8192
    v_mfma_f32_32x32x16_bf16 v[32:47], a[8:11], v[104:107], v[32:47]
    buffer_load_dwordx4 v13, s[36:39], s51 offen offset:1024 sc1 lds
    ds_read_b128 v[96:99], v2 offset:9216
    v_mfma_f32_32x32x16_bf16 v[32:47], a[12:15], v[108:111], v[32:47]
    ds_read_b128 v[100:103], v2 offset:10240
    s_waitcnt lgkmcnt(3)
    v_mfma_f32_32x32x16_bf16 v[32:47], a[16:19], v[112:115], v[32:47]
    ds_read_b128 v[104:107], v2 offset:11264
    v_mfma_f32_32x32x16_bf16 v[32:47], a[20:23], v[116:119], v[32:47]
    ds_read_b128 v[108:111], v2 offset:12288
    buffer_load_dwordx4 v[212:215], v8, s[36:39], s9 offen offset:1024 sc1
    v_mfma_f32_32x32x16_bf16 v[32:47], a[24:27], a[224:227], v[32:47]
    ds_read_b128 v[112:115], v2 offset:13312
    v_mfma_f32_32x32x16_bf16 v[32:47], a[28:31], a[228:231], v[32:47]
    ds_read_b128 v[116:119], v2 offset:14336
    s_waitcnt lgkmcnt(3)
    buffer_load_dwordx4 v[216:219], v8, s[36:39], s9 offen offset:2048 sc1
    v_mfma_f32_32x32x16_bf16 v[32:47], a[32:35], a[232:235], v[32:47]
    ds_read_b128 a[224:227], v2 offset:15360
    v_mfma_f32_32x32x16_bf16 v[32:47], a[36:39], v[96:99], v[32:47]
    s_waitcnt vmcnt(12)
    s_barrier
    ds_read_b128 a[228:231], v2 offset:16384
    buffer_load_dwordx4 v[220:223], v8, s[36:39], s9 offen offset:3072 sc1
    v_mfma_f32_32x32x16_bf16 v[32:47], a[40:43], v[100:103], v[32:47]
    ds_read_b128 a[232:235], v2 offset:17408
    v_mfma_f32_32x32x16_bf16 v[32:47], a[44:47], v[104:107], v[32:47]
    s_waitcnt vmcnt(9)
    s_barrier
    ds_read_b128 v[96:99], v2 offset:18432
    s_waitcnt lgkmcnt(3)
    ds_read2st64_b64 v[64:67], v18 offset0:56 offset1:57
    ds_read2st64_b64 v[68:71], v18 offset0:58 offset1:59
    buffer_load_dwordx4 v[224:227], v8, s[36:39], s10 offen offset:0 sc1
    v_mfma_f32_32x32x16_bf16 v[32:47], a[48:51], v[108:111], v[32:47]
    ds_read_b128 v[100:103], v2 offset:19456
    ds_read2st64_b64 v[72:75], v18 offset0:60 offset1:61
    ds_read2st64_b64 v[76:79], v18 offset0:62 offset1:63
    v_mfma_f32_32x32x16_bf16 v[32:47], a[52:55], v[112:115], v[32:47]
    ds_read_b128 v[104:107], v2 offset:20480
    ds_read2st64_b64 v[80:83], v18 offset0:64 offset1:65
    ds_read2st64_b64 v[84:87], v18 offset0:66 offset1:67
    buffer_load_dwordx4 v[228:231], v8, s[36:39], s10 offen offset:1024 sc1
    v_mfma_f32_32x32x16_bf16 v[32:47], a[56:59], v[116:119], v[32:47]
    ds_read_b128 v[108:111], v2 offset:21504
    ds_read2st64_b64 v[88:91], v18 offset0:68 offset1:69
    v_mfma_f32_32x32x16_bf16 v[32:47], a[60:63], a[224:227], v[32:47]
    ds_read_b128 v[112:115], v2 offset:22528
    s_waitcnt lgkmcnt(8)
    buffer_load_dwordx4 v[232:235], v8, s[36:39], s10 offen offset:2048 sc1
    v_mfma_f32_32x32x16_bf16 v[32:47], a[64:67], a[228:231], v[32:47]
    ds_read_b128 v[116:119], v2 offset:23552
    s_waitcnt lgkmcnt(2)
    v_add_f32 v64, v64, v66
    v_add_f32 v68, v68, v70
    v_add_f32 v72, v72, v74
    v_add_f32 v76, v76, v78
    v_mfma_f32_32x32x16_bf16 v[32:47], a[68:71], a[232:235], v[32:47]
    ds_read_b128 a[224:227], v2 offset:24576
    buffer_load_dwordx4 v[236:239], v8, s[36:39], s10 offen offset:3072 sc1
    v_add_f32 v80, v80, v82
    v_add_f32 v84, v84, v86
    v_add_f32 v88, v88, v90
    v_add_f32 v65, v65, v67
    v_mfma_f32_32x32x16_bf16 v[32:47], a[72:75], v[96:99], v[32:47]
    ds_read_b128 a[228:231], v2 offset:25600
    v_add_f32 v69, v69, v71
    v_add_f32 v73, v73, v75
    v_add_f32 v77, v77, v79
    v_add_f32 v81, v81, v83
    v_add_f32 v85, v85, v87
    v_mfma_f32_32x32x16_bf16 v[32:47], a[76:79], v[100:103], v[32:47]
    ds_read_b128 a[232:235], v2 offset:26624
    s_waitcnt lgkmcnt(3)
    buffer_load_dwordx4 a[200:203], v2, s[36:39], s58 offen offset:2048 sc1
    v_add_f32 v89, v89, v91
    v_add_f32 v64, v64, v68
    v_add_f32 v72, v72, v76
    v_mfma_f32_32x32x16_bf16 v[32:47], a[80:83], v[104:107], v[32:47]
    ds_read_b128 v[96:99], v2 offset:27648
    v_add_f32 v80, v80, v84
    v_add_f32 v65, v65, v69
    v_add_f32 v73, v73, v77
    v_add_f32 v81, v81, v85
    v_add_f32 v64, v64, v72
    v_mfma_f32_32x32x16_bf16 v[32:47], a[84:87], v[108:111], v[32:47]
    ds_read_b128 v[100:103], v2 offset:35840
    buffer_load_dwordx4 a[204:207], v2, s[36:39], s58 offen offset:3072 sc1
    v_add_f32 v80, v80, v88
    v_add_f32 v65, v65, v73
    v_add_f32 v81, v81, v89
    v_add_f32 v64, v64, v80
    v_mfma_f32_32x32x16_bf16 v[32:47], a[88:91], v[112:115], v[32:47]
    ds_read_b128 v[104:107], v2 offset:36864
    v_add_f32 v65, v65, v81
    v_mul_f32 v64, 0xbb124925, v64
    v_mul_f32 v65, 0x3b124925, v65
    v_cvt_pk_bf16_f32 v241, v64, 0
    v_fma_f32 v65, -v64, v64, v65
    v_mfma_f32_32x32x16_bf16 v[32:47], a[92:95], v[116:119], v[32:47]
    ds_read_b128 v[108:111], v2 offset:37888
    s_waitcnt lgkmcnt(3)
    s_add_u32 s58, s58, 4096
    buffer_load_dwordx4 a[208:211], v2, s[36:39], s58 offen offset:0 sc1
    v_lshlrev_b32 v26, 16, v241
    v_max_f32 v65, 0, v65
    v_sub_f32 v26, v64, v26
    v_mfma_f32_32x32x16_bf16 v[32:47], a[96:99], a[224:227], v[32:47]
    ds_read_b128 v[112:115], v2 offset:38912
    v_add_f32 v65, 0x3727c5ac, v65
    v_cvt_pk_bf16_f32 v240, v64, v26
    v_rsq_f32 v24, v65
    v_mov_b32 v245, v241
    v_mfma_f32_32x32x16_bf16 v[32:47], a[100:103], a[228:231], v[32:47]
    ds_read_b128 v[116:119], v2 offset:39936
    buffer_load_dwordx4 a[212:215], v2, s[36:39], s58 offen offset:1024 sc1
    v_mov_b32 v244, v240
    v_mov_b32 v25, v24
    v_lshrrev_b32 v26, 2, v2
    v_add_u32 v26, 86016, v26
    v_mfma_f32_32x32x16_bf16 v[32:47], a[104:107], a[232:235], v[32:47]
    s_waitcnt vmcnt(15)
    s_barrier
    ds_read_b128 a[224:227], v2 offset:40960
    ds_write_b32 v26, v24
    v_permlane32_swap_b32 v241, v245
    v_permlane32_swap_b32 v240, v244
    v_mfma_f32_32x32x16_bf16 v[32:47], a[108:111], v[96:99], v[32:47]
    ds_read_b128 a[228:231], v2 offset:41984
    s_waitcnt lgkmcnt(4)
    buffer_load_dwordx4 a[216:219], v2, s[36:39], s58 offen offset:2048 sc1
    v_permlane32_swap_b32 v24, v25
    v_mfma_f32_32x32x16_bf16 v[32:47], v[120:123], v[240:243], v[32:47]
    v_mul_f32 v20, 0xc0135761, v24
    v_mul_f32 v22, v24, v24
    v_mul_f32 v22, v22, v20
    v_mul_f32 v22, 0x3d372713, v22
    v_mfma_f32_32x32x16_bf16 v[48:63], a[0:3], v[100:103], 0
    ds_read_b128 a[232:235], v2 offset:43008
    v_mul_f32 v21, 0xc0135761, v25
    v_mul_f32 v23, v25, v25
    v_mul_f32 v23, v23, v21
    v_mul_f32 v23, 0x3d372713, v23
    buffer_load_dwordx4 a[220:223], v2, s[36:39], s58 offen offset:3072 sc1
    v_mfma_f32_32x32x16_bf16 v[48:63], a[4:7], v[104:107], v[48:63]
    ds_read_b128 v[96:99], v2 offset:44032
    v_mfma_f32_32x32x16_bf16 v[48:63], a[8:11], v[108:111], v[48:63]
    ds_read_b128 v[100:103], v2 offset:45056
    buffer_load_dwordx4 a[0:3], v9, s[36:39], s4 offen offset:0 sc1
    v_mul_f32 v248, v32, v32
    v_mul_f32 v249, v33, v33
    v_mul_f32 v250, v34, v34
    v_mul_f32 v251, v35, v35
    v_fma_f32 v248, v248, v22, v20
    v_mfma_f32_32x32x16_bf16 v[48:63], a[12:15], v[112:115], v[48:63]
    ds_read_b128 v[104:107], v2 offset:46080
    s_waitcnt lgkmcnt(3)
    v_fma_f32 v249, v249, v22, v20
    v_fma_f32 v250, v250, v22, v20
    v_fma_f32 v251, v251, v22, v20
    v_mul_f32 v248, v248, v32
    v_mul_f32 v249, v249, v33
    v_mul_f32 v250, v250, v34
    v_mfma_f32_32x32x16_bf16 v[48:63], a[16:19], v[116:119], v[48:63]
    ds_read_b128 v[108:111], v2 offset:47104
    buffer_load_dwordx4 a[4:7], v9, s[36:39], s4 offen offset:1024 sc1
    v_mul_f32 v251, v251, v35
    v_exp_f32 v248, v248
    v_exp_f32 v249, v249
    v_mfma_f32_32x32x16_bf16 v[48:63], a[20:23], a[224:227], v[48:63]
    ds_read_b128 v[112:115], v2 offset:48128
    v_exp_f32 v250, v250
    v_exp_f32 v251, v251
    v_add_f32 v248, 1.0, v248
    v_add_f32 v249, 1.0, v249
    v_add_f32 v250, 1.0, v250
    v_mfma_f32_32x32x16_bf16 v[48:63], a[24:27], a[228:231], v[48:63]
    s_waitcnt vmcnt(15)
    s_barrier
    ds_read_b128 v[116:119], v2 offset:49152
    buffer_load_dwordx4 a[8:11], v9, s[36:39], s4 offen offset:2048 sc1
    v_add_f32 v251, 1.0, v251
    v_rcp_f32 v248, v248
    v_mfma_f32_32x32x16_bf16 v[48:63], a[28:31], a[232:235], v[48:63]
    ds_read_b128 a[224:227], v2 offset:50176
    s_waitcnt lgkmcnt(3)
    v_rcp_f32 v249, v249
    v_rcp_f32 v250, v250
    v_rcp_f32 v251, v251
    v_mfma_f32_32x32x16_bf16 v[48:63], a[32:35], v[96:99], v[48:63]
    ds_read_b128 a[228:231], v2 offset:51200
    buffer_load_dwordx4 a[12:15], v9, s[36:39], s4 offen offset:3072 sc1
    v_mul_f32 v248, v248, v32
    v_mul_f32 v249, v249, v33
    v_mul_f32 v250, v250, v34
    v_mul_f32 v251, v251, v35
    v_cvt_pk_bf16_f32 v64, v248, v249
    v_mfma_f32_32x32x16_bf16 v[48:63], a[36:39], v[100:103], v[48:63]
    ds_read_b128 a[232:235], v2 offset:52224
    v_cvt_pk_bf16_f32 v65, v250, v251
    v_mul_f32 v252, v36, v36
    v_mul_f32 v253, v37, v37
    v_mul_f32 v254, v38, v38
    v_mul_f32 v255, v39, v39
    v_fma_f32 v252, v252, v22, v20
    v_fma_f32 v253, v253, v22, v20
    v_mfma_f32_32x32x16_bf16 v[48:63], a[40:43], v[104:107], v[48:63]
    ds_read_b128 v[96:99], v2 offset:53248
    buffer_load_dwordx4 a[16:19], v9, s[36:39], s5 offen offset:0 sc1
    v_fma_f32 v254, v254, v22, v20
    v_fma_f32 v255, v255, v22, v20
    v_mul_f32 v252, v252, v36
    v_mul_f32 v253, v253, v37
    v_mul_f32 v254, v254, v38
    v_mul_f32 v255, v255, v39
    v_mfma_f32_32x32x16_bf16 v[48:63], a[44:47], v[108:111], v[48:63]
    ds_read_b128 v[100:103], v2 offset:54272
    s_waitcnt lgkmcnt(3)
    v_exp_f32 v252, v252
    v_exp_f32 v253, v253
    v_mfma_f32_32x32x16_bf16 v[48:63], a[48:51], v[112:115], v[48:63]
    ds_read_b128 v[104:107], v2 offset:55296
    buffer_load_dwordx4 a[20:23], v9, s[36:39], s5 offen offset:1024 sc1
    v_exp_f32 v254, v254
    v_exp_f32 v255, v255
    v_add_f32 v252, 1.0, v252
    v_add_f32 v253, 1.0, v253
    v_add_f32 v254, 1.0, v254
    v_mfma_f32_32x32x16_bf16 v[48:63], a[52:55], v[116:119], v[48:63]
    ds_read_b128 v[108:111], v2 offset:56320
    v_add_f32 v255, 1.0, v255
    v_rcp_f32 v252, v252
    v_rcp_f32 v253, v253
    v_mfma_f32_32x32x16_bf16 v[48:63], a[56:59], a[224:227], v[48:63]
    ds_read_b128 v[112:115], v2 offset:57344
    buffer_load_dwordx4 a[24:27], v9, s[36:39], s5 offen offset:2048 sc1
    v_rcp_f32 v254, v254
    v_rcp_f32 v255, v255
    v_mul_f32 v252, v252, v36
    v_mul_f32 v253, v253, v37
    v_mul_f32 v254, v254, v38
    v_mfma_f32_32x32x16_bf16 v[48:63], a[60:63], a[228:231], v[48:63]
    ds_read_b128 v[116:119], v2 offset:58368
    s_waitcnt lgkmcnt(3)
    v_mul_f32 v255, v255, v39
    v_cvt_pk_bf16_f32 v66, v252, v253
    v_cvt_pk_bf16_f32 v67, v254, v255
    v_mfma_f32_32x32x16_bf16 v[48:63], a[64:67], a[232:235], v[48:63]
    buffer_store_dwordx4 v[64:67], v10, s[36:39], s4 offen offset:0 sc1
    ds_read_b128 a[224:227], v2 offset:59392
    buffer_load_dwordx4 a[28:31], v9, s[36:39], s5 offen offset:3072 sc1
    v_mul_f32 v248, v40, v40
    v_mul_f32 v249, v41, v41
    v_mul_f32 v250, v42, v42
    v_mul_f32 v251, v43, v43
    v_fma_f32 v248, v248, v22, v20
    v_fma_f32 v249, v249, v22, v20
    v_fma_f32 v250, v250, v22, v20
    v_mfma_f32_32x32x16_bf16 v[48:63], a[68:71], v[96:99], v[48:63]
    ds_read_b128 a[228:231], v2 offset:60416
    v_fma_f32 v251, v251, v22, v20
    v_mul_f32 v248, v248, v40
    v_mul_f32 v249, v249, v41
    v_mul_f32 v250, v250, v42
    v_mul_f32 v251, v251, v43
    v_mfma_f32_32x32x16_bf16 v[48:63], a[72:75], v[100:103], v[48:63]
    ds_read_b128 a[232:235], v2 offset:61440
    buffer_load_dwordx4 a[32:35], v9, s[36:39], s6 offen offset:0 sc1
    v_exp_f32 v248, v248
    v_exp_f32 v249, v249
    v_exp_f32 v250, v250
    v_mfma_f32_32x32x16_bf16 v[48:63], a[76:79], v[104:107], v[48:63]
    ds_read_b128 v[96:99], v2 offset:62464
    s_waitcnt lgkmcnt(3)
    v_exp_f32 v251, v251
    v_add_f32 v248, 1.0, v248
    v_add_f32 v249, 1.0, v249
    v_add_f32 v250, 1.0, v250
    v_add_f32 v251, 1.0, v251
    v_mfma_f32_32x32x16_bf16 v[48:63], a[80:83], v[108:111], v[48:63]
    ds_read_b128 v[100:103], v2 offset:63488
    buffer_load_dwordx4 a[36:39], v9, s[36:39], s6 offen offset:1024 sc1
    v_rcp_f32 v248, v248
    v_rcp_f32 v249, v249
    v_rcp_f32 v250, v250
    v_mfma_f32_32x32x16_bf16 v[48:63], a[84:87], v[112:115], v[48:63]
    ds_read_b128 v[104:107], v2 offset:0
    v_rcp_f32 v251, v251
    v_mul_f32 v248, v248, v40
    v_mul_f32 v249, v249, v41
    v_mul_f32 v250, v250, v42
    v_mul_f32 v251, v251, v43
    v_cvt_pk_bf16_f32 v68, v248, v249
K_PGB1:
    s_cbranch_execz K_WRB
    s_nop 0
    v_mfma_f32_32x32x16_bf16 v[48:63], a[88:91], v[116:119], v[48:63]
    ds_read_b128 v[108:111], v2 offset:1024
    buffer_load_dwordx4 a[40:43], v9, s[36:39], s6 offen offset:2048 sc1
    v_cvt_pk_bf16_f32 v69, v250, v251
    v_mul_f32 v252, v44, v44
    v_mul_f32 v253, v45, v45
    v_mul_f32 v254, v46, v46
    v_mul_f32 v255, v47, v47
    v_mfma_f32_32x32x16_bf16 v[48:63], a[92:95], a[224:227], v[48:63]
    ds_read_b128 v[112:115], v2 offset:2048
    s_waitcnt lgkmcnt(3)
    v_fma_f32 v252, v252, v22, v20
    v_fma_f32 v253, v253, v22, v20
    v_fma_f32 v254, v254, v22, v20
    v_fma_f32 v255, v255, v22, v20
    v_mul_f32 v252, v252, v44
    v_mul_f32 v253, v253, v45
    v_mfma_f32_32x32x16_bf16 v[48:63], a[96:99], a[228:231], v[48:63]
    ds_read_b128 v[116:119], v2 offset:3072
    buffer_load_dwordx4 a[44:47], v9, s[36:39], s6 offen offset:3072 sc1
    v_mul_f32 v254, v254, v46
    v_mul_f32 v255, v255, v47
    v_exp_f32 v252, v252
    v_mfma_f32_32x32x16_bf16 v[48:63], a[100:103], a[232:235], v[48:63]
    ds_read_b128 a[224:227], v2 offset:4096
    v_exp_f32 v253, v253
    v_exp_f32 v254, v254
    v_exp_f32 v255, v255
    v_add_f32 v252, 1.0, v252
    v_add_f32 v253, 1.0, v253
    v_mfma_f32_32x32x16_bf16 v[48:63], a[104:107], v[96:99], v[48:63]
    ds_read_b128 a[228:231], v2 offset:5120
    buffer_load_dwordx4 a[48:51], v9, s[36:39], s7 offen offset:0 sc1
    v_add_f32 v254, 1.0, v254
    v_add_f32 v255, 1.0, v255
    v_rcp_f32 v252, v252
    v_mfma_f32_32x32x16_bf16 v[48:63], a[108:111], v[100:103], v[48:63]
    ds_read_b128 a[232:235], v2 offset:6144
    s_waitcnt lgkmcnt(3)
    v_rcp_f32 v253, v253
    v_rcp_f32 v254, v254
    v_rcp_f32 v255, v255
    v_mul_f32 v252, v252, v44
    v_mfma_f32_32x32x16_bf16 v[48:63], v[120:123], v[244:247], v[48:63]
    buffer_load_dwordx4 a[52:55], v9, s[36:39], s7 offen offset:1024 sc1
    s_waitcnt vmcnt(15)
    v_mul_f32 v253, v253, v45
    v_mul_f32 v254, v254, v46
    v_mul_f32 v255, v255, v47
    v_cvt_pk_bf16_f32 v70, v252, v253
    v_cvt_pk_bf16_f32 v71, v254, v255
    buffer_store_dwordx4 v[68:71], v10, s[36:39], s4 offen offset:1024 sc1
    v_mfma_f32_32x32x16_bf16 v[32:47], a[112:115], v[104:107], 0
    ds_read_b128 v[96:99], v2 offset:7168
    v_mfma_f32_32x32x16_bf16 v[32:47], a[116:119], v[108:111], v[32:47]
    ds_read_b128 v[100:103], v2 offset:8192
    buffer_load_dwordx4 a[56:59], v9, s[36:39], s7 offen offset:2048 sc1
    v_mfma_f32_32x32x16_bf16 v[32:47], a[120:123], v[112:115], v[32:47]
    ds_read_b128 v[104:107], v2 offset:9216
    v_mul_f32 v248, v48, v48
    v_mul_f32 v249, v49, v49
    v_mul_f32 v250, v50, v50
    v_mul_f32 v251, v51, v51
    v_fma_f32 v248, v248, v23, v21
    v_fma_f32 v249, v249, v23, v21
    v_mfma_f32_32x32x16_bf16 v[32:47], a[124:127], v[116:119], v[32:47]
    ds_read_b128 v[108:111], v2 offset:10240
    s_waitcnt lgkmcnt(3)
    buffer_load_dwordx4 a[60:63], v9, s[36:39], s7 offen offset:3072 sc1
    v_fma_f32 v250, v250, v23, v21
    v_fma_f32 v251, v251, v23, v21
    v_mul_f32 v248, v248, v48
    v_mul_f32 v249, v249, v49
    v_mul_f32 v250, v250, v50
    v_mfma_f32_32x32x16_bf16 v[32:47], a[128:131], a[224:227], v[32:47]
    ds_read_b128 v[112:115], v2 offset:11264
    v_mul_f32 v251, v251, v51
    v_exp_f32 v248, v248
    v_exp_f32 v249, v249
    v_mfma_f32_32x32x16_bf16 v[32:47], a[132:135], a[228:231], v[32:47]
    ds_read_b128 v[116:119], v2 offset:12288
    buffer_load_dwordx4 a[64:67], v9, s[36:39], s8 offen offset:0 sc1
    v_exp_f32 v250, v250
    v_exp_f32 v251, v251
    v_add_f32 v248, 1.0, v248
    v_add_f32 v249, 1.0, v249
    v_add_f32 v250, 1.0, v250
    v_mfma_f32_32x32x16_bf16 v[32:47], a[136:139], a[232:235], v[32:47]
    ds_read_b128 a[224:227], v2 offset:13312
    v_add_f32 v251, 1.0, v251
    v_rcp_f32 v248, v248
    v_rcp_f32 v249, v249
    v_mfma_f32_32x32x16_bf16 v[32:47], a[140:143], v[96:99], v[32:47]
    ds_read_b128 a[228:231], v2 offset:14336
    s_waitcnt lgkmcnt(3)
    buffer_load_dwordx4 a[68:71], v9, s[36:39], s8 offen offset:1024 sc1
    v_rcp_f32 v250, v250
    v_rcp_f32 v251, v251
    v_mul_f32 v248, v248, v48
    v_mul_f32 v249, v249, v49
    v_mfma_f32_32x32x16_bf16 v[32:47], a[144:147], v[100:103], v[32:47]
    ds_read_b128 a[232:235], v2 offset:15360
    v_mul_f32 v250, v250, v50
    v_mul_f32 v251, v251, v51
    v_cvt_pk_bf16_f32 v72, v248, v249
    v_cvt_pk_bf16_f32 v73, v250, v251
    v_mul_f32 v252, v52, v52
    v_mul_f32 v253, v53, v53
    v_mul_f32 v254, v54, v54
    v_mfma_f32_32x32x16_bf16 v[32:47], a[148:151], v[104:107], v[32:47]
    ds_read_b128 v[96:99], v2 offset:16384
    buffer_load_dwordx4 a[72:75], v9, s[36:39], s8 offen offset:2048 sc1
    v_mul_f32 v255, v55, v55
    v_fma_f32 v252, v252, v23, v21
    v_fma_f32 v253, v253, v23, v21
    v_fma_f32 v254, v254, v23, v21
    v_fma_f32 v255, v255, v23, v21
    v_mfma_f32_32x32x16_bf16 v[32:47], a[152:155], v[108:111], v[32:47]
    ds_read_b128 v[100:103], v2 offset:17408
    v_mul_f32 v252, v252, v52
    v_mul_f32 v253, v253, v53
    v_mul_f32 v254, v254, v54
    v_mul_f32 v255, v255, v55
    v_exp_f32 v252, v252
    v_mfma_f32_32x32x16_bf16 v[32:47], a[156:159], v[112:115], v[32:47]
    ds_read_b128 v[104:107], v2 offset:18432
    s_waitcnt lgkmcnt(3)
    buffer_load_dwordx4 a[76:79], v9, s[36:39], s8 offen offset:3072 sc1
    v_exp_f32 v253, v253
    v_exp_f32 v254, v254
    v_mfma_f32_32x32x16_bf16 v[32:47], a[160:163], v[116:119], v[32:47]
    ds_read_b128 v[108:111], v2 offset:19456
    v_exp_f32 v255, v255
    v_add_f32 v252, 1.0, v252
    v_add_f32 v253, 1.0, v253
    v_add_f32 v254, 1.0, v254
    v_add_f32 v255, 1.0, v255
    v_rcp_f32 v252, v252
    v_mfma_f32_32x32x16_bf16 v[32:47], a[164:167], a[224:227], v[32:47]
    ds_read_b128 v[112:115], v2 offset:20480
    buffer_load_dwordx4 a[80:83], v9, s[36:39], s9 offen offset:0 sc1
    v_rcp_f32 v253, v253
    v_rcp_f32 v254, v254
    v_rcp_f32 v255, v255
    v_mfma_f32_32x32x16_bf16 v[32:47], a[168:171], a[228:231], v[32:47]
    ds_read_b128 v[116:119], v2 offset:21504
    s_waitcnt vmcnt(7)
    s_mov_b64 exec, 15
    buffer_store_dword v28, v29, s[36:39], s19 offen offset:0
    s_mov_b64 exec, -1
    v_mul_f32 v252, v252, v52
    v_mfma_f32_32x32x16_bf16 v[32:47], a[172:175], a[232:235], v[32:47]
    ds_read_b128 a[224:227], v2 offset:22528
    s_waitcnt lgkmcnt(3)
    buffer_load_dwordx4 a[84:87], v9, s[36:39], s9 offen offset:1024 sc1
    v_mul_f32 v253, v253, v53
    v_mul_f32 v254, v254, v54
    v_mul_f32 v255, v255, v55
    v_cvt_pk_bf16_f32 v74, v252, v253
    v_cvt_pk_bf16_f32 v75, v254, v255
    v_mfma_f32_32x32x16_bf16 v[32:47], a[176:179], v[96:99], v[32:47]
    buffer_store_dwordx4 v[72:75], v10, s[36:39], s4 offen offset:2048 sc1
    ds_read_b128 a[228:231], v2 offset:23552
    v_mul_f32 v248, v56, v56
    v_mul_f32 v249, v57, v57
    v_mul_f32 v250, v58, v58
    v_mul_f32 v251, v59, v59
    v_fma_f32 v248, v248, v23, v21
    v_mfma_f32_32x32x16_bf16 v[32:47], a[180:183], v[100:103], v[32:47]
    ds_read_b128 a[232:235], v2 offset:24576
    buffer_load_dwordx4 a[88:91], v9, s[36:39], s9 offen offset:2048 sc1
    v_fma_f32 v249, v249, v23, v21
    v_fma_f32 v250, v250, v23, v21
    v_fma_f32 v251, v251, v23, v21
    v_mul_f32 v248, v248, v56
    v_mul_f32 v249, v249, v57
    v_mul_f32 v250, v250, v58
    v_mfma_f32_32x32x16_bf16 v[32:47], a[184:187], v[104:107], v[32:47]
    ds_read_b128 v[96:99], v2 offset:25600
    v_mul_f32 v251, v251, v59
    v_exp_f32 v248, v248
    v_exp_f32 v249, v249
    v_exp_f32 v250, v250
    v_mfma_f32_32x32x16_bf16 v[32:47], a[188:191], v[108:111], v[32:47]
    ds_read_b128 v[100:103], v2 offset:26624
    s_waitcnt lgkmcnt(3)
    buffer_load_dwordx4 a[92:95], v9, s[36:39], s9 offen offset:3072 sc1
    v_exp_f32 v251, v251
    v_add_f32 v248, 1.0, v248
    v_add_f32 v249, 1.0, v249
    v_mfma_f32_32x32x16_bf16 v[32:47], a[192:195], v[112:115], v[32:47]
    ds_read_b128 v[104:107], v2 offset:27648
    v_add_f32 v250, 1.0, v250
    v_add_f32 v251, 1.0, v251
    v_rcp_f32 v248, v248
    v_rcp_f32 v249, v249
    v_mfma_f32_32x32x16_bf16 v[32:47], a[196:199], v[116:119], v[32:47]
    ds_read_b128 v[108:111], v2 offset:35840
    buffer_load_dwordx4 a[96:99], v9, s[36:39], s10 offen offset:0 sc1
    v_rcp_f32 v250, v250
    v_rcp_f32 v251, v251
    v_mul_f32 v248, v248, v56
    v_mul_f32 v249, v249, v57
    v_mfma_f32_32x32x16_bf16 v[32:47], a[200:203], a[224:227], v[32:47]
    ds_read_b128 v[112:115], v2 offset:36864
    v_mul_f32 v250, v250, v58
    v_mul_f32 v251, v251, v59
    v_cvt_pk_bf16_f32 v76, v248, v249
    v_cvt_pk_bf16_f32 v77, v250, v251
    v_mul_f32 v252, v60, v60
    v_mul_f32 v253, v61, v61
    v_mul_f32 v254, v62, v62
    v_mfma_f32_32x32x16_bf16 v[32:47], a[204:207], a[228:231], v[32:47]
    ds_read_b128 v[116:119], v2 offset:37888
    s_waitcnt lgkmcnt(3)
    buffer_load_dwordx4 a[100:103], v9, s[36:39], s10 offen offset:1024 sc1
    v_mul_f32 v255, v63, v63
    v_fma_f32 v252, v252, v23, v21
    v_fma_f32 v253, v253, v23, v21
    v_fma_f32 v254, v254, v23, v21
    v_fma_f32 v255, v255, v23, v21
    v_mfma_f32_32x32x16_bf16 v[32:47], a[208:211], a[232:235], v[32:47]
    ds_read_b128 a[224:227], v2 offset:38912
    v_mul_f32 v252, v252, v60
    v_mul_f32 v253, v253, v61
    v_mul_f32 v254, v254, v62
    v_mul_f32 v255, v255, v63
    v_exp_f32 v252, v252
    v_mfma_f32_32x32x16_bf16 v[32:47], a[212:215], v[96:99], v[32:47]
    ds_read_b128 a[228:231], v2 offset:39936
    buffer_load_dwordx4 a[104:107], v9, s[36:39], s10 offen offset:2048 sc1
    v_exp_f32 v253, v253
    v_exp_f32 v254, v254
    v_exp_f32 v255, v255
    v_mfma_f32_32x32x16_bf16 v[32:47], a[216:219], v[100:103], v[32:47]
    ds_read_b128 a[232:235], v2 offset:40960
    v_add_f32 v252, 1.0, v252
    v_add_f32 v253, 1.0, v253
    v_add_f32 v254, 1.0, v254
    v_add_f32 v255, 1.0, v255
    v_rcp_f32 v252, v252
    v_mfma_f32_32x32x16_bf16 v[32:47], a[220:223], v[104:107], v[32:47]
    ds_read_b128 v[96:99], v2 offset:41984
    s_waitcnt lgkmcnt(3)
    buffer_load_dwordx4 a[108:111], v9, s[36:39], s10 offen offset:3072 sc1
    v_rcp_f32 v253, v253
    v_rcp_f32 v254, v254
    v_mfma_f32_32x32x16_bf16 v[32:47], v[124:127], v[240:243], v[32:47]
    v_rcp_f32 v255, v255
    v_mul_f32 v252, v252, v60
    v_mul_f32 v253, v253, v61
    v_mul_f32 v254, v254, v62
    v_mul_f32 v255, v255, v63
    v_cvt_pk_bf16_f32 v78, v252, v253
    v_cvt_pk_bf16_f32 v79, v254, v255
    buffer_store_dwordx4 v[76:79], v10, s[36:39], s4 offen offset:3072 sc1
    v_mfma_f32_32x32x16_bf16 v[48:63], a[112:115], v[108:111], 0
    ds_read_b128 v[100:103], v2 offset:43008
    v_mfma_f32_32x32x16_bf16 v[48:63], a[116:119], v[112:115], v[48:63]
    ds_read_b128 v[104:107], v2 offset:44032
    s_load_dwordx8 s[20:27], s[32:33], s50 offset:0
    v_mfma_f32_32x32x16_bf16 v[48:63], a[120:123], v[116:119], v[48:63]
    ds_read_b128 v[108:111], v2 offset:45056
    v_mul_f32 v248, v32, v32
    v_mul_f32 v249, v33, v33
    v_mul_f32 v250, v34, v34
    v_mul_f32 v251, v35, v35
    v_fma_f32 v248, v248, v22, v20
    v_fma_f32 v249, v249, v22, v20
    v_mfma_f32_32x32x16_bf16 v[48:63], a[124:127], a[224:227], v[48:63]
    ds_read_b128 v[112:115], v2 offset:46080
    s_waitcnt lgkmcnt(3)
    v_fma_f32 v250, v250, v22, v20
    v_fma_f32 v251, v251, v22, v20
    v_mul_f32 v248, v248, v32
    v_mul_f32 v249, v249, v33
    v_mul_f32 v250, v250, v34
    v_mfma_f32_32x32x16_bf16 v[48:63], a[128:131], a[228:231], v[48:63]
    ds_read_b128 v[116:119], v2 offset:47104
    v_mul_f32 v251, v251, v35
    v_exp_f32 v248, v248
    v_exp_f32 v249, v249
    v_exp_f32 v250, v250
    v_mfma_f32_32x32x16_bf16 v[48:63], a[132:135], a[232:235], v[48:63]
    ds_read_b128 a[224:227], v2 offset:48128
    v_exp_f32 v251, v251
    v_add_f32 v248, 1.0, v248
    v_add_f32 v249, 1.0, v249
    v_add_f32 v250, 1.0, v250
    v_add_f32 v251, 1.0, v251
    v_mfma_f32_32x32x16_bf16 v[48:63], a[136:139], v[96:99], v[48:63]
    s_waitcnt lgkmcnt(0)
    s_and_b64 s[20:21], s[20:21], s[22:23]
    s_and_b64 s[20:21], s[20:21], s[24:25]
    s_and_b32 s20, s20, s21
    s_and_b32 s20, s20, s26
    s_cbranch_scc0 K_P_3s
K_P_3r:
    ds_read_b128 a[228:231], v2 offset:49152
    buffer_load_dwordx4 a[112:115], v10, s[36:39], s5 offen offset:0 sc1
    v_rcp_f32 v248, v248
    v_mfma_f32_32x32x16_bf16 v[48:63], a[140:143], v[100:103], v[48:63]
    ds_read_b128 a[232:235], v2 offset:50176
    s_waitcnt lgkmcnt(3)
    v_rcp_f32 v249, v249
    v_rcp_f32 v250, v250
    v_mfma_f32_32x32x16_bf16 v[48:63], a[144:147], v[104:107], v[48:63]
    ds_read_b128 v[96:99], v2 offset:51200
    buffer_load_dwordx4 a[116:119], v10, s[36:39], s5 offen offset:1024 sc1
    v_rcp_f32 v251, v251
    v_mul_f32 v248, v248, v32
    v_mul_f32 v249, v249, v33
    v_mul_f32 v250, v250, v34
    v_mul_f32 v251, v251, v35
    v_cvt_pk_bf16_f32 v80, v248, v249
    v_mfma_f32_32x32x16_bf16 v[48:63], a[148:151], v[108:111], v[48:63]
    ds_read_b128 v[100:103], v2 offset:52224
    v_cvt_pk_bf16_f32 v81, v250, v251
    v_mul_f32 v252, v36, v36
    v_mul_f32 v253, v37, v37
    v_mul_f32 v254, v38, v38
    v_mul_f32 v255, v39, v39
    v_fma_f32 v252, v252, v22, v20
    v_mfma_f32_32x32x16_bf16 v[48:63], a[152:155], v[112:115], v[48:63]
    ds_read_b128 v[104:107], v2 offset:53248
    buffer_load_dwordx4 a[120:123], v10, s[36:39], s6 offen offset:0 sc1
    v_fma_f32 v253, v253, v22, v20
    v_fma_f32 v254, v254, v22, v20
    v_fma_f32 v255, v255, v22, v20
    v_mul_f32 v252, v252, v36
    v_mul_f32 v253, v253, v37
    v_mul_f32 v254, v254, v38
    v_mfma_f32_32x32x16_bf16 v[48:63], a[156:159], v[116:119], v[48:63]
    ds_read_b128 v[108:111], v2 offset:54272
    s_waitcnt lgkmcnt(3)
    v_mul_f32 v255, v255, v39
    v_exp_f32 v252, v252
    v_exp_f32 v253, v253
    v_mfma_f32_32x32x16_bf16 v[48:63], a[160:163], a[224:227], v[48:63]
    ds_read_b128 v[112:115], v2 offset:55296
    buffer_load_dwordx4 a[124:127], v10, s[36:39], s6 offen offset:1024 sc1
    v_exp_f32 v254, v254
    v_exp_f32 v255, v255
    v_add_f32 v252, 1.0, v252
    v_mfma_f32_32x32x16_bf16 v[48:63], a[164:167], a[228:231], v[48:63]
    ds_read_b128 v[116:119], v2 offset:56320
    v_add_f32 v253, 1.0, v253
    v_add_f32 v254, 1.0, v254
    v_add_f32 v255, 1.0, v255
    v_rcp_f32 v252, v252
    v_rcp_f32 v253, v253
    v_mfma_f32_32x32x16_bf16 v[48:63], a[168:171], a[232:235], v[48:63]
    ds_read_b128 a[224:227], v2 offset:57344
    buffer_load_dwordx4 a[128:131], v10, s[36:39], s7 offen offset:0 sc1
    v_rcp_f32 v254, v254
    v_rcp_f32 v255, v255
    v_mul_f32 v252, v252, v36
    v_mfma_f32_32x32x16_bf16 v[48:63], a[172:175], v[96:99], v[48:63]
    ds_read_b128 a[228:231], v2 offset:58368
    s_waitcnt lgkmcnt(3)
    v_mul_f32 v253, v253, v37
    v_mul_f32 v254, v254, v38
    v_mul_f32 v255, v255, v39
    v_cvt_pk_bf16_f32 v82, v252, v253
    v_cvt_pk_bf16_f32 v83, v254, v255
    v_mfma_f32_32x32x16_bf16 v[48:63], a[176:179], v[100:103], v[48:63]
    buffer_store_dwordx4 v[80:83], v11, s[36:39], s4 offen offset:0 sc1
    ds_read_b128 a[232:235], v2 offset:59392
    buffer_load_dwordx4 a[132:135], v10, s[36:39], s7 offen offset:1024 sc1
    v_mul_f32 v248, v40, v40
    v_mul_f32 v249, v41, v41
    v_mul_f32 v250, v42, v42
    v_mul_f32 v251, v43, v43
    v_fma_f32 v248, v248, v22, v20
    v_mfma_f32_32x32x16_bf16 v[48:63], a[180:183], v[104:107], v[48:63]
    ds_read_b128 v[96:99], v2 offset:60416
    v_fma_f32 v249, v249, v22, v20
    v_fma_f32 v250, v250, v22, v20
    v_fma_f32 v251, v251, v22, v20
    v_mul_f32 v248, v248, v40
    v_mul_f32 v249, v249, v41
    v_mul_f32 v250, v250, v42
    v_mul_f32 v251, v251, v43
    v_mfma_f32_32x32x16_bf16 v[48:63], a[184:187], v[108:111], v[48:63]
    ds_read_b128 v[100:103], v2 offset:61440
    buffer_load_dwordx4 a[136:139], v10, s[36:39], s8 offen offset:0 sc1
    v_exp_f32 v248, v248
    v_exp_f32 v249, v249
    v_mfma_f32_32x32x16_bf16 v[48:63], a[188:191], v[112:115], v[48:63]
    ds_read_b128 v[104:107], v2 offset:62464
    s_waitcnt lgkmcnt(3)
    v_exp_f32 v250, v250
    v_exp_f32 v251, v251
    v_add_f32 v248, 1.0, v248
    v_add_f32 v249, 1.0, v249
    v_add_f32 v250, 1.0, v250
    v_mfma_f32_32x32x16_bf16 v[48:63], a[192:195], v[116:119], v[48:63]
    ds_read_b128 v[108:111], v2 offset:63488
    buffer_load_dwordx4 a[140:143], v10, s[36:39], s8 offen offset:1024 sc1
    v_add_f32 v251, 1.0, v251
    v_rcp_f32 v248, v248
    v_rcp_f32 v249, v249
    v_mfma_f32_32x32x16_bf16 v[48:63], a[196:199], a[224:227], v[48:63]
    v_rcp_f32 v250, v250
    v_rcp_f32 v251, v251
    v_mul_f32 v248, v248, v40
    v_mul_f32 v249, v249, v41
    v_mul_f32 v250, v250, v42
    v_mfma_f32_32x32x16_bf16 v[48:63], a[200:203], a[228:231], v[48:63]
    buffer_load_dwordx4 a[144:147], v10, s[36:39], s9 offen offset:0 sc1
    s_waitcnt vmcnt(10)
    s_mov_b64 exec, 15
    buffer_store_dword v28, v29, s[36:39], s19 offen offset:256
    s_mov_b64 exec, -1
    v_mul_f32 v251, v251, v43
    v_cvt_pk_bf16_f32 v84, v248, v249
    v_mfma_f32_32x32x16_bf16 v[48:63], a[204:207], a[232:235], v[48:63]
    s_waitcnt lgkmcnt(0)
    v_cvt_pk_bf16_f32 v85, v250, v251
    v_mul_f32 v252, v44, v44
    v_mul_f32 v253, v45, v45
    v_mul_f32 v254, v46, v46
    v_mul_f32 v255, v47, v47
    v_fma_f32 v252, v252, v22, v20
    v_mfma_f32_32x32x16_bf16 v[48:63], a[208:211], v[96:99], v[48:63]
    buffer_load_dwordx4 a[148:151], v10, s[36:39], s9 offen offset:1024 sc1
    v_fma_f32 v253, v253, v22, v20
    v_fma_f32 v254, v254, v22, v20
    v_fma_f32 v255, v255, v22, v20
    v_mul_f32 v252, v252, v44
    v_mul_f32 v253, v253, v45
    v_mul_f32 v254, v254, v46
    v_mul_f32 v255, v255, v47
    v_mfma_f32_32x32x16_bf16 v[48:63], a[212:215], v[100:103], v[48:63]
    v_exp_f32 v252, v252
    v_exp_f32 v253, v253
    v_exp_f32 v254, v254
    v_mfma_f32_32x32x16_bf16 v[48:63], a[216:219], v[104:107], v[48:63]
    buffer_load_dwordx4 a[152:155], v10, s[36:39], s10 offen offset:0 sc1
    v_exp_f32 v255, v255
    v_add_f32 v252, 1.0, v252
    v_add_f32 v253, 1.0, v253
    v_add_f32 v254, 1.0, v254
    v_add_f32 v255, 1.0, v255
    v_rcp_f32 v252, v252
    v_mfma_f32_32x32x16_bf16 v[48:63], a[220:223], v[108:111], v[48:63]
    v_rcp_f32 v253, v253
    v_rcp_f32 v254, v254
    v_rcp_f32 v255, v255
    v_mul_f32 v252, v252, v44
    v_mfma_f32_32x32x16_bf16 v[48:63], v[124:127], v[244:247], v[48:63]
    s_waitcnt vmcnt(52)
    buffer_load_dwordx4 a[156:159], v10, s[36:39], s10 offen offset:1024 sc1
    v_mul_f32 v253, v253, v45
    v_mul_f32 v254, v254, v46
    v_mul_f32 v255, v255, v47
    v_cvt_pk_bf16_f32 v86, v252, v253
    v_cvt_pk_bf16_f32 v87, v254, v255
    buffer_store_dwordx4 v[84:87], v11, s[36:39], s4 offen offset:1024 sc1
    v_mfma_f32_32x32x16_bf16 a[176:191], v[128:131], v[64:67], 0
    v_mfma_f32_32x32x16_bf16 a[192:207], v[132:135], v[64:67], 0
    s_nop 1
    v_mul_f32 v248, v48, v48
    v_mul_f32 v249, v49, v49
    v_mul_f32 v250, v50, v50
    v_mul_f32 v251, v51, v51
    v_fma_f32 v248, v248, v23, v21
    v_fma_f32 v249, v249, v23, v21
    v_fma_f32 v250, v250, v23, v21
    v_fma_f32 v251, v251, v23, v21
    v_mul_f32 v248, v248, v48
    v_mul_f32 v249, v249, v49
    v_mul_f32 v250, v250, v50
    v_mul_f32 v251, v251, v51
    v_exp_f32 v248, v248
    v_mfma_f32_32x32x16_bf16 a[176:191], v[136:139], v[68:71], a[176:191]
    v_exp_f32 v249, v249
    v_exp_f32 v250, v250
    v_exp_f32 v251, v251
    v_add_f32 v248, 1.0, v248
    v_add_f32 v249, 1.0, v249
    v_add_f32 v250, 1.0, v250
    v_add_f32 v251, 1.0, v251
    v_rcp_f32 v248, v248
    v_rcp_f32 v249, v249
    v_mfma_f32_32x32x16_bf16 a[192:207], v[140:143], v[68:71], a[192:207]
    v_rcp_f32 v250, v250
    v_rcp_f32 v251, v251
    v_mul_f32 v248, v248, v48
    v_mul_f32 v249, v249, v49
    v_mul_f32 v250, v250, v50
    v_mul_f32 v251, v251, v51
    v_cvt_pk_bf16_f32 v88, v248, v249
    v_cvt_pk_bf16_f32 v89, v250, v251
    v_mul_f32 v252, v52, v52
    v_mul_f32 v253, v53, v53
    v_mul_f32 v254, v54, v54
    v_mul_f32 v255, v55, v55
    v_mfma_f32_32x32x16_bf16 a[208:223], v[128:131], v[72:75], 0
    v_fma_f32 v252, v252, v23, v21
    v_fma_f32 v253, v253, v23, v21
    v_fma_f32 v254, v254, v23, v21
    v_fma_f32 v255, v255, v23, v21
    v_mul_f32 v252, v252, v52
    v_mul_f32 v253, v253, v53
    v_mul_f32 v254, v254, v54
    v_mul_f32 v255, v255, v55
    v_exp_f32 v252, v252
    v_exp_f32 v253, v253
    v_exp_f32 v254, v254
    v_mfma_f32_32x32x16_bf16 a[224:239], v[132:135], v[72:75], 0
    v_exp_f32 v255, v255
    v_add_f32 v252, 1.0, v252
    v_add_f32 v253, 1.0, v253
    v_add_f32 v254, 1.0, v254
    v_add_f32 v255, 1.0, v255
    v_rcp_f32 v252, v252
    v_rcp_f32 v253, v253
    v_rcp_f32 v254, v254
    v_rcp_f32 v255, v255
    v_mfma_f32_32x32x16_bf16 a[208:223], v[136:139], v[76:79], a[208:223]
    v_mul_f32 v252, v252, v52
    v_mul_f32 v253, v253, v53
    v_mul_f32 v254, v254, v54
    v_mul_f32 v255, v255, v55
    v_cvt_pk_bf16_f32 v90, v252, v253
    v_cvt_pk_bf16_f32 v91, v254, v255
    v_mfma_f32_32x32x16_bf16 a[224:239], v[140:143], v[76:79], a[224:239]
    buffer_store_dwordx4 v[88:91], v11, s[36:39], s4 offen offset:2048 sc1
    s_waitcnt vmcnt(45)
    v_mul_f32 v248, v56, v56
    v_mul_f32 v249, v57, v57
    v_mul_f32 v250, v58, v58
    v_mul_f32 v251, v59, v59
    v_fma_f32 v248, v248, v23, v21
    v_fma_f32 v249, v249, v23, v21
    v_fma_f32 v250, v250, v23, v21
    v_fma_f32 v251, v251, v23, v21
    v_mul_f32 v248, v248, v56
    v_mul_f32 v249, v249, v57
    v_mul_f32 v250, v250, v58
    v_mul_f32 v251, v251, v59
    v_exp_f32 v248, v248
    v_exp_f32 v249, v249
    v_exp_f32 v250, v250
    v_exp_f32 v251, v251
    v_add_f32 v248, 1.0, v248
    v_mfma_f32_32x32x16_bf16 a[176:191], a[0:3], v[80:83], a[176:191]
    v_add_f32 v249, 1.0, v249
    v_add_f32 v250, 1.0, v250
    v_add_f32 v251, 1.0, v251
    v_rcp_f32 v248, v248
    v_rcp_f32 v249, v249
    v_rcp_f32 v250, v250
    v_rcp_f32 v251, v251
    v_mul_f32 v248, v248, v56
    v_mul_f32 v249, v249, v57
    v_mul_f32 v250, v250, v58
    v_mfma_f32_32x32x16_bf16 a[192:207], a[4:7], v[80:83], a[192:207]
    v_mul_f32 v251, v251, v59
    v_cvt_pk_bf16_f32 v92, v248, v249
    v_cvt_pk_bf16_f32 v93, v250, v251
    v_mul_f32 v252, v60, v60
    v_mul_f32 v253, v61, v61
    v_mul_f32 v254, v62, v62
    v_mul_f32 v255, v63, v63
    v_fma_f32 v252, v252, v23, v21
    v_fma_f32 v253, v253, v23, v21
    v_fma_f32 v254, v254, v23, v21
    v_fma_f32 v255, v255, v23, v21
    v_mul_f32 v252, v252, v60
    v_mul_f32 v253, v253, v61
    v_mul_f32 v254, v254, v62
    v_mfma_f32_32x32x16_bf16 a[176:191], a[8:11], v[84:87], a[176:191]
    s_load_dwordx8 s[20:27], s[32:33], s50 offset:256
    v_mul_f32 v255, v255, v63
    v_exp_f32 v252, v252
    v_exp_f32 v253, v253
    v_exp_f32 v254, v254
    v_exp_f32 v255, v255
    v_add_f32 v252, 1.0, v252
    v_add_f32 v253, 1.0, v253
    v_add_f32 v254, 1.0, v254
    v_add_f32 v255, 1.0, v255
    v_mfma_f32_32x32x16_bf16 a[192:207], a[12:15], v[84:87], a[192:207]
    v_rcp_f32 v252, v252
    v_rcp_f32 v253, v253
    v_rcp_f32 v254, v254
    v_rcp_f32 v255, v255
    v_mul_f32 v252, v252, v60
    v_mul_f32 v253, v253, v61
    v_mul_f32 v254, v254, v62
    v_mul_f32 v255, v255, v63
    v_cvt_pk_bf16_f32 v94, v252, v253
    v_cvt_pk_bf16_f32 v95, v254, v255
    buffer_store_dwordx4 v[92:95], v11, s[36:39], s4 offen offset:3072 sc1
    v_mfma_f32_32x32x16_bf16 a[208:223], a[0:3], v[88:91], a[208:223]
    s_waitcnt vmcnt(2)
    s_mov_b64 exec, 15
    buffer_store_dword v28, v29, s[36:39], s19 offen offset:512
    s_mov_b64 exec, -1
    v_mfma_f32_32x32x16_bf16 a[224:239], a[4:7], v[88:91], a[224:239]
    v_mfma_f32_32x32x16_bf16 a[208:223], a[8:11], v[92:95], a[208:223]
    s_waitcnt lgkmcnt(0)
    s_and_b64 s[20:21], s[20:21], s[22:23]
    s_and_b64 s[20:21], s[20:21], s[24:25]
    s_and_b32 s20, s20, s21
    s_and_b32 s20, s20, s26
    s_cbranch_scc0 K_P_4s
K_P_4r:
    buffer_load_dwordx4 a[160:163], v10, s[36:39], s5 offen offset:2048 sc1
    v_mfma_f32_32x32x16_bf16 a[224:239], a[12:15], v[92:95], a[224:239]
    v_add_u32 v3, s15, v2
    s_waitcnt vmcnt(17)
    v_mfma_f32_32x32x16_bf16 a[176:191], v[144:147], a[112:115], a[176:191]
    buffer_load_dwordx4 a[164:167], v10, s[36:39], s5 offen offset:3072 sc1
    v_mfma_f32_32x32x16_bf16 a[192:207], v[148:151], a[112:115], a[192:207]
    v_mfma_f32_32x32x16_bf16 a[176:191], v[152:155], a[116:119], a[176:191]
    buffer_load_dwordx4 a[168:171], v10, s[36:39], s6 offen offset:2048 sc1
    v_mfma_f32_32x32x16_bf16 a[192:207], v[156:159], a[116:119], a[192:207]
    s_waitcnt vmcnt(17)
    v_mfma_f32_32x32x16_bf16 a[176:191], v[160:163], a[120:123], a[176:191]
    buffer_load_dwordx4 a[172:175], v10, s[36:39], s6 offen offset:3072 sc1
    v_mfma_f32_32x32x16_bf16 a[192:207], v[164:167], a[120:123], a[192:207]
    v_mfma_f32_32x32x16_bf16 a[176:191], v[168:171], a[124:127], a[176:191]
    buffer_load_dwordx4 a[240:243], v10, s[36:39], s7 offen offset:2048 sc1
    v_mfma_f32_32x32x16_bf16 a[192:207], v[172:175], a[124:127], a[192:207]
    s_waitcnt vmcnt(16)
    v_mfma_f32_32x32x16_bf16 a[176:191], v[176:179], a[128:131], a[176:191]
    buffer_load_dwordx4 a[244:247], v10, s[36:39], s7 offen offset:3072 sc1
    v_mfma_f32_32x32x16_bf16 a[192:207], v[180:183], a[128:131], a[192:207]
    v_mfma_f32_32x32x16_bf16 a[176:191], v[184:187], a[132:135], a[176:191]
    buffer_load_dwordx4 a[248:251], v10, s[36:39], s8 offen offset:2048 sc1
    v_mfma_f32_32x32x16_bf16 a[192:207], v[188:191], a[132:135], a[192:207]
    s_waitcnt vmcnt(16)
    s_load_dwordx8 s[20:27], s[32:33], s50 offset:512
    s_waitcnt vmcnt(8)
    s_mov_b64 exec, 15
    buffer_store_dword v28, v29, s[36:39], s19 offen offset:768
    s_mov_b64 exec, -1
    v_mfma_f32_32x32x16_bf16 a[176:191], v[192:195], a[136:139], a[176:191]
    buffer_load_dwordx4 a[252:255], v10, s[36:39], s8 offen offset:3072 sc1
    v_mfma_f32_32x32x16_bf16 a[192:207], v[196:199], a[136:139], a[192:207]
    v_mfma_f32_32x32x16_bf16 a[176:191], v[200:203], a[140:143], a[176:191]
    buffer_load_dwordx4 v[96:99], v10, s[36:39], s9 offen offset:2048 sc1
    v_mfma_f32_32x32x16_bf16 a[192:207], v[204:207], a[140:143], a[192:207]
    s_waitcnt vmcnt(16)
    v_mfma_f32_32x32x16_bf16 a[176:191], v[208:211], a[144:147], a[176:191]
    buffer_load_dwordx4 v[100:103], v10, s[36:39], s9 offen offset:3072 sc1
    v_mfma_f32_32x32x16_bf16 a[192:207], v[212:215], a[144:147], a[192:207]
    v_mfma_f32_32x32x16_bf16 a[176:191], v[216:219], a[148:151], a[176:191]
    s_waitcnt lgkmcnt(0)
    s_and_b64 s[20:21], s[20:21], s[22:23]
    s_and_b64 s[20:21], s[20:21], s[24:25]
    s_and_b32 s20, s20, s21
    s_and_b32 s20, s20, s26
    s_cbranch_scc0 K_P_5s
K_P_5r:
    buffer_load_dwordx4 v[104:107], v10, s[36:39], s10 offen offset:2048 sc1
    buffer_load_dwordx4 a[112:115], v11, s[36:39], s5 offen offset:0 sc1
    v_mfma_f32_32x32x16_bf16 a[192:207], v[220:223], a[148:151], a[192:207]
    s_waitcnt vmcnt(17)
    v_mfma_f32_32x32x16_bf16 a[176:191], v[224:227], a[152:155], a[176:191]
    buffer_load_dwordx4 v[108:111], v10, s[36:39], s10 offen offset:3072 sc1
    buffer_load_dwordx4 a[116:119], v11, s[36:39], s5 offen offset:1024 sc1
    v_mfma_f32_32x32x16_bf16 a[192:207], v[228:231], a[152:155], a[192:207]
    v_mfma_f32_32x32x16_bf16 a[176:191], v[232:235], a[156:159], a[176:191]
    buffer_load_dwordx4 a[120:123], v11, s[36:39], s6 offen offset:0 sc1
    v_mfma_f32_32x32x16_bf16 a[192:207], v[236:239], a[156:159], a[192:207]
    s_waitcnt vmcnt(14)
    v_mfma_f32_32x32x16_bf16 a[208:223], v[144:147], a[160:163], a[208:223]
    buffer_load_dwordx4 a[124:127], v11, s[36:39], s6 offen offset:1024 sc1
    v_mfma_f32_32x32x16_bf16 a[224:239], v[148:151], a[160:163], a[224:239]
    v_mfma_f32_32x32x16_bf16 a[208:223], v[152:155], a[164:167], a[208:223]
    buffer_load_dwordx4 a[128:131], v11, s[36:39], s7 offen offset:0 sc1
    v_mfma_f32_32x32x16_bf16 a[224:239], v[156:159], a[164:167], a[224:239]
    s_waitcnt vmcnt(14)
    v_mfma_f32_32x32x16_bf16 a[208:223], v[160:163], a[168:171], a[208:223]
    buffer_load_dwordx4 a[132:135], v11, s[36:39], s7 offen offset:1024 sc1
    v_mfma_f32_32x32x16_bf16 a[224:239], v[164:167], a[168:171], a[224:239]
    v_mfma_f32_32x32x16_bf16 a[208:223], v[168:171], a[172:175], a[208:223]
    buffer_load_dwordx4 a[136:139], v11, s[36:39], s8 offen offset:0 sc1
    v_mfma_f32_32x32x16_bf16 a[224:239], v[172:175], a[172:175], a[224:239]
    s_waitcnt vmcnt(14)
    s_load_dwordx8 s[20:27], s[32:33], s50 offset:768
    v_mfma_f32_32x32x16_bf16 a[208:223], v[176:179], a[240:243], a[208:223]
    buffer_load_dwordx4 a[140:143], v11, s[36:39], s8 offen offset:1024 sc1
    v_mfma_f32_32x32x16_bf16 a[224:239], v[180:183], a[240:243], a[224:239]
    v_mfma_f32_32x32x16_bf16 a[208:223], v[184:187], a[244:247], a[208:223]
    buffer_load_dwordx4 a[144:147], v11, s[36:39], s9 offen offset:0 sc1
    v_mfma_f32_32x32x16_bf16 a[224:239], v[188:191], a[244:247], a[224:239]
    s_waitcnt vmcnt(13)
    v_mfma_f32_32x32x16_bf16 a[208:223], v[192:195], a[248:251], a[208:223]
    buffer_load_dwordx4 a[148:151], v11, s[36:39], s9 offen offset:1024 sc1
    v_mfma_f32_32x32x16_bf16 a[224:239], v[196:199], a[248:251], a[224:239]
    v_mfma_f32_32x32x16_bf16 a[208:223], v[200:203], a[252:255], a[208:223]
    s_waitcnt lgkmcnt(0)
    s_and_b64 s[20:21], s[20:21], s[22:23]
    s_and_b64 s[20:21], s[20:21], s[24:25]
    s_and_b32 s20, s20, s21
    s_and_b32 s20, s20, s26
    s_cbranch_scc0 K_P_6s
K_P_6r:
    buffer_load_dwordx4 a[152:155], v11, s[36:39], s10 offen offset:0 sc1
K_PGB2:
    s_cbranch_execz K_WRB
    s_nop 0
    buffer_load_dwordx4 a[160:163], v11, s[36:39], s5 offen offset:2048 sc1
    v_mfma_f32_32x32x16_bf16 a[224:239], v[204:207], a[252:255], a[224:239]
    s_waitcnt vmcnt(14)
    v_mfma_f32_32x32x16_bf16 a[208:223], v[208:211], v[96:99], a[208:223]
    buffer_load_dwordx4 a[156:159], v11, s[36:39], s10 offen offset:1024 sc1
    buffer_load_dwordx4 a[164:167], v11, s[36:39], s5 offen offset:3072 sc1
    v_mfma_f32_32x32x16_bf16 a[224:239], v[212:215], v[96:99], a[224:239]
    v_mfma_f32_32x32x16_bf16 a[208:223], v[216:219], v[100:103], a[208:223]
    buffer_load_dwordx4 a[168:171], v11, s[36:39], s6 offen offset:2048 sc1
    v_mfma_f32_32x32x16_bf16 a[224:239], v[220:223], v[100:103], a[224:239]
    s_waitcnt vmcnt(14)
    v_mfma_f32_32x32x16_bf16 a[208:223], v[224:227], v[104:107], a[208:223]
    buffer_load_dwordx4 a[172:175], v11, s[36:39], s6 offen offset:3072 sc1
    v_mfma_f32_32x32x16_bf16 a[224:239], v[228:231], v[104:107], a[224:239]
    v_mfma_f32_32x32x16_bf16 a[208:223], v[232:235], v[108:111], a[208:223]
    buffer_load_dwordx4 a[240:243], v11, s[36:39], s7 offen offset:2048 sc1
    v_lshrrev_b32 v4, 3, v0
    v_mfma_f32_32x32x16_bf16 a[224:239], v[236:239], v[108:111], a[224:239]
    s_waitcnt vmcnt(49)
    s_waitcnt vmcnt(15)
    v_lshlrev_b32 v6, 4, v4
    v_mfma_f32_32x32x16_bf16 a[176:191], a[16:19], a[112:115], a[176:191]
    buffer_load_dwordx4 a[244:247], v11, s[36:39], s7 offen offset:3072 sc1
    v_and_b32 v5, 3, v0
    v_mfma_f32_32x32x16_bf16 a[192:207], a[20:23], a[112:115], a[192:207]
    v_mul_u32_u24 v5, 1088, v5
    v_mfma_f32_32x32x16_bf16 a[176:191], a[24:27], a[116:119], a[176:191]
    buffer_load_dwordx4 a[248:251], v11, s[36:39], s8 offen offset:2048 sc1
    v_add_u32 v6, v6, v5
    v_mfma_f32_32x32x16_bf16 a[192:207], a[28:31], a[116:119], a[192:207]
    s_waitcnt vmcnt(15)
    v_bfe_u32 v5, v0, 2, 1
    v_mfma_f32_32x32x16_bf16 a[176:191], a[32:35], a[120:123], a[176:191]
    buffer_load_dwordx4 a[252:255], v11, s[36:39], s8 offen offset:3072 sc1
    v_mul_u32_u24 v13, 4352, v5
    v_mfma_f32_32x32x16_bf16 a[192:207], a[36:39], a[120:123], a[192:207]
    v_add_u32 v14, v13, v6
    v_mfma_f32_32x32x16_bf16 a[176:191], a[40:43], a[124:127], a[176:191]
    buffer_load_dwordx4 v[96:99], v11, s[36:39], s9 offen offset:2048 sc1
    v_add_u32 v6, 90112, v14
    v_mfma_f32_32x32x16_bf16 a[192:207], a[44:47], a[124:127], a[192:207]
    s_waitcnt vmcnt(15)
    v_add_u32 v14, 65536, v14
    v_mfma_f32_32x32x16_bf16 a[176:191], a[48:51], a[128:131], a[176:191]
    buffer_load_dwordx4 v[100:103], v11, s[36:39], s9 offen offset:3072 sc1
    v_lshlrev_b32 v4, 2, v4
    v_mfma_f32_32x32x16_bf16 a[192:207], a[52:55], a[128:131], a[192:207]
    v_add_u32 v4, 86016, v4
    v_mfma_f32_32x32x16_bf16 a[176:191], a[56:59], a[132:135], a[176:191]
    buffer_load_dwordx4 v[104:107], v11, s[36:39], s10 offen offset:2048 sc1
    ds_read2_b32 v[24:25], v4 offset0:0 offset1:32
    v_mfma_f32_32x32x16_bf16 a[192:207], a[60:63], a[132:135], a[192:207]
    s_waitcnt vmcnt(15)
    ds_read_b128 v[32:35], v14 offset:0
    v_mfma_f32_32x32x16_bf16 a[176:191], a[64:67], a[136:139], a[176:191]
    buffer_load_dwordx4 v[108:111], v11, s[36:39], s10 offen offset:3072 sc1
    ds_read_b128 v[36:39], v14 offset:512
    v_mfma_f32_32x32x16_bf16 a[192:207], a[68:71], a[136:139], a[192:207]
    ds_read_b128 v[40:43], v14 offset:8704
    v_mfma_f32_32x32x16_bf16 a[176:191], a[72:75], a[140:143], a[176:191]
    ds_read_b128 v[44:47], v14 offset:9216
    v_mfma_f32_32x32x16_bf16 a[192:207], a[76:79], a[140:143], a[192:207]
    s_waitcnt vmcnt(14)
    v_mfma_f32_32x32x16_bf16 a[176:191], a[80:83], a[144:147], a[176:191]
    v_mfma_f32_32x32x16_bf16 a[192:207], a[84:87], a[144:147], a[192:207]
    v_mfma_f32_32x32x16_bf16 a[176:191], a[88:91], a[148:151], a[176:191]
    v_mfma_f32_32x32x16_bf16 a[192:207], a[92:95], a[148:151], a[192:207]
    s_waitcnt vmcnt(11)
    v_mfma_f32_32x32x16_bf16 a[176:191], a[96:99], a[152:155], a[176:191]
    v_mfma_f32_32x32x16_bf16 a[192:207], a[100:103], a[152:155], a[192:207]
    v_mfma_f32_32x32x16_bf16 a[176:191], a[104:107], a[156:159], a[176:191]
    v_mfma_f32_32x32x16_bf16 a[192:207], a[108:111], a[156:159], a[192:207]
    s_waitcnt vmcnt(10)
    v_mfma_f32_32x32x16_bf16 a[208:223], a[16:19], a[160:163], a[208:223]
    v_lshlrev_b32 v29, 2, v29
    s_mov_b64 exec, 15
    buffer_store_dword v28, v29, s[36:39], s59 offen sc1
    buffer_store_dword v28, off, s[36:39], s56 sc1
    s_mov_b64 exec, -1
    v_mfma_f32_32x32x16_bf16 a[224:239], a[20:23], a[160:163], a[224:239]
    v_mfma_f32_32x32x16_bf16 a[208:223], a[24:27], a[164:167], a[208:223]
    v_mfma_f32_32x32x16_bf16 a[224:239], a[28:31], a[164:167], a[224:239]
    s_waitcnt vmcnt(10)
    ds_write_b128 v3, a[176:179] offset:0
    v_mfma_f32_32x32x16_bf16 a[208:223], a[32:35], a[168:171], a[208:223]
    ds_write_b128 v3, a[180:183] offset:1088
    v_mfma_f32_32x32x16_bf16 a[224:239], a[36:39], a[168:171], a[224:239]
    ds_write_b128 v3, a[184:187] offset:2176
    v_mfma_f32_32x32x16_bf16 a[208:223], a[40:43], a[172:175], a[208:223]
    ds_write_b128 v3, a[188:191] offset:3264
    v_mfma_f32_32x32x16_bf16 a[224:239], a[44:47], a[172:175], a[224:239]
    s_waitcnt vmcnt(8)
    ds_write_b128 v3, a[192:195] offset:4352
    v_mfma_f32_32x32x16_bf16 a[208:223], a[48:51], a[240:243], a[208:223]
    ds_write_b128 v3, a[196:199] offset:5440
    v_mfma_f32_32x32x16_bf16 a[224:239], a[52:55], a[240:243], a[224:239]
    ds_write_b128 v3, a[200:203] offset:6528
    v_mfma_f32_32x32x16_bf16 a[208:223], a[56:59], a[244:247], a[208:223]
    ds_write_b128 v3, a[204:207] offset:7616
    v_mfma_f32_32x32x16_bf16 a[224:239], a[60:63], a[244:247], a[224:239]
    s_waitcnt vmcnt(6)
    v_mfma_f32_32x32x16_bf16 a[208:223], a[64:67], a[248:251], a[208:223]
    s_waitcnt lgkmcnt(0)
    s_barrier
    ds_read_b128 v[128:131], v6 offset:0
    ds_read_b128 v[132:135], v6 offset:17408
    ds_read_b128 v[136:139], v6 offset:34816
    ds_read_b128 v[140:143], v6 offset:52224
    v_mfma_f32_32x32x16_bf16 a[208:223], a[72:75], a[252:255], a[208:223]
    s_waitcnt vmcnt(4)
    ds_read_b128 v[144:147], v6 offset:512
    ds_read_b128 v[148:151], v6 offset:17920
    ds_read_b128 v[152:155], v6 offset:35328
    ds_read_b128 v[156:159], v6 offset:52736
    v_mfma_f32_32x32x16_bf16 a[208:223], a[80:83], v[96:99], a[208:223]
    v_mfma_f32_32x32x16_bf16 a[208:223], a[88:91], v[100:103], a[208:223]
    s_waitcnt vmcnt(2)
    v_mfma_f32_32x32x16_bf16 a[208:223], a[96:99], v[104:107], a[208:223]
    s_waitcnt lgkmcnt(0)
    v_add_f32 v128, v128, v132
    v_add_f32 v129, v129, v133
    v_add_f32 v130, v130, v134
    v_add_f32 v131, v131, v135
    v_add_f32 v136, v136, v140
    v_mfma_f32_32x32x16_bf16 a[208:223], a[104:107], v[108:111], a[208:223]
    v_add_f32 v137, v137, v141
    v_add_f32 v138, v138, v142
    v_add_f32 v139, v139, v143
    v_add_f32 v128, v128, v136
    v_add_f32 v129, v129, v137
    v_add_f32 v130, v130, v138
    v_mfma_f32_32x32x16_bf16 a[224:239], a[68:71], a[248:251], a[224:239]
    v_add_f32 v131, v131, v139
    v_fma_f32 v128, v128, v24, v32
    v_fma_f32 v129, v129, v24, v33
    v_fma_f32 v130, v130, v24, v34
    v_fma_f32 v131, v131, v24, v35
    v_add_f32 v144, v144, v148
    v_mfma_f32_32x32x16_bf16 a[224:239], a[76:79], a[252:255], a[224:239]
    v_add_f32 v145, v145, v149
    v_add_f32 v146, v146, v150
    v_add_f32 v147, v147, v151
    v_add_f32 v152, v152, v156
    v_add_f32 v153, v153, v157
    v_add_f32 v154, v154, v158
    v_mfma_f32_32x32x16_bf16 a[224:239], a[84:87], v[96:99], a[224:239]
    ds_write_b128 v3, a[208:211] offset:8704
    v_add_f32 v155, v155, v159
    v_add_f32 v144, v144, v152
    v_add_f32 v145, v145, v153
    v_add_f32 v146, v146, v154
    v_add_f32 v147, v147, v155
    v_mfma_f32_32x32x16_bf16 a[224:239], a[92:95], v[100:103], a[224:239]
    ds_write_b128 v3, a[212:215] offset:9792
    v_fma_f32 v144, v144, v24, v36
    v_fma_f32 v145, v145, v24, v37
    v_fma_f32 v146, v146, v24, v38
    v_fma_f32 v147, v147, v24, v39
    v_cvt_pk_bf16_f32 v48, v128, v129
    v_mfma_f32_32x32x16_bf16 a[224:239], a[100:103], v[104:107], a[224:239]
    ds_write_b128 v3, a[216:219] offset:10880
    v_cvt_pk_bf16_f32 v49, v130, v131
    v_cvt_pk_bf16_f32 v50, v144, v145
    v_cvt_pk_bf16_f32 v51, v146, v147
    global_store_dwordx4 v16, v[48:51], s[28:29] nt
    v_mfma_f32_32x32x16_bf16 a[224:239], a[108:111], v[108:111], a[224:239]
    ds_write_b128 v3, a[220:223] offset:11968
    s_nop 10
    ds_write_b128 v3, a[224:227] offset:13056
    ds_write_b128 v3, a[228:231] offset:14144
    ds_write_b128 v3, a[232:235] offset:15232
    ds_write_b128 v3, a[236:239] offset:16320
    v_add_u32 v16, 28672, v16
    s_waitcnt lgkmcnt(0)
    s_barrier
    s_nop 0
    ds_read_b128 v[128:131], v6 offset:8704
    ds_read_b128 v[132:135], v6 offset:26112
    ds_read_b128 v[136:139], v6 offset:43520
    ds_read_b128 v[140:143], v6 offset:60928
    ds_read_b128 v[144:147], v6 offset:9216
    ds_read_b128 v[148:151], v6 offset:26624
    ds_read_b128 v[152:155], v6 offset:44032
    ds_read_b128 v[156:159], v6 offset:61440
    s_waitcnt lgkmcnt(4)
    s_nop 0
    v_pk_add_f32 v[128:129], v[128:129], v[132:133]
    v_pk_add_f32 v[130:131], v[130:131], v[134:135]
    v_pk_add_f32 v[136:137], v[136:137], v[140:141]
    v_pk_add_f32 v[138:139], v[138:139], v[142:143]
    v_pk_add_f32 v[128:129], v[128:129], v[136:137]
    v_pk_add_f32 v[130:131], v[130:131], v[138:139]
    v_pk_fma_f32 v[128:129], v[128:129], v[24:25], v[40:41] op_sel:[0,1,0] op_sel_hi:[1,1,1]
    v_pk_fma_f32 v[130:131], v[130:131], v[24:25], v[42:43] op_sel:[0,1,0] op_sel_hi:[1,1,1]
    s_waitcnt lgkmcnt(0)
    s_nop 0
    v_pk_add_f32 v[144:145], v[144:145], v[148:149]
    v_pk_add_f32 v[146:147], v[146:147], v[150:151]
    v_pk_add_f32 v[152:153], v[152:153], v[156:157]
    v_pk_add_f32 v[154:155], v[154:155], v[158:159]
    v_pk_add_f32 v[144:145], v[144:145], v[152:153]
    v_pk_add_f32 v[146:147], v[146:147], v[154:155]
    v_pk_fma_f32 v[144:145], v[144:145], v[24:25], v[44:45] op_sel:[0,1,0] op_sel_hi:[1,1,1]
    v_pk_fma_f32 v[146:147], v[146:147], v[24:25], v[46:47] op_sel:[0,1,0] op_sel_hi:[1,1,1]
    v_cvt_pk_bf16_f32 v52, v128, v129
    v_cvt_pk_bf16_f32 v53, v130, v131
    v_cvt_pk_bf16_f32 v54, v144, v145
    v_cvt_pk_bf16_f32 v55, v146, v147
    global_store_dwordx4 v16, v[52:55], s[28:29] nt
K_END:
    s_endpgm
K_PGB3:
    s_cbranch_execz K_WRB
    s_nop 0
K_P_3s:
    s_load_dwordx8 s[20:27], s[32:33], s50 offset:64
    s_waitcnt lgkmcnt(0)
    s_and_b64 s[20:21], s[20:21], s[22:23]
    s_and_b64 s[20:21], s[20:21], s[24:25]
    s_and_b32 s20, s20, s21
    s_and_b32 s20, s20, s26
    s_cbranch_scc1 K_P_3r
    s_load_dwordx8 s[20:27], s[32:33], s50 offset:128
    s_waitcnt lgkmcnt(0)
    s_and_b64 s[20:21], s[20:21], s[22:23]
    s_and_b64 s[20:21], s[20:21], s[24:25]
    s_and_b32 s20, s20, s21
    s_and_b32 s20, s20, s26
    s_cbranch_scc1 K_P_3r
    s_load_dwordx8 s[20:27], s[32:33], s50 offset:192
    s_waitcnt lgkmcnt(0)
    s_and_b64 s[20:21], s[20:21], s[22:23]
    s_and_b64 s[20:21], s[20:21], s[24:25]
    s_and_b32 s20, s20, s21
    s_and_b32 s20, s20, s26
    s_cbranch_scc1 K_P_3r
    s_branch K_P_3v
K_P_4s:
    s_load_dwordx8 s[20:27], s[32:33], s50 offset:320
    s_waitcnt lgkmcnt(0)
    s_and_b64 s[20:21], s[20:21], s[22:23]
    s_and_b64 s[20:21], s[20:21], s[24:25]
    s_and_b32 s20, s20, s21
    s_and_b32 s20, s20, s26
    s_cbranch_scc1 K_P_4r
    s_load_dwordx8 s[20:27], s[32:33], s50 offset:384
    s_waitcnt lgkmcnt(0)
    s_and_b64 s[20:21], s[20:21], s[22:23]
    s_and_b64 s[20:21], s[20:21], s[24:25]
    s_and_b32 s20, s20, s21
    s_and_b32 s20, s20, s26
    s_cbranch_scc1 K_P_4r
    s_load_dwordx8 s[20:27], s[32:33], s50 offset:448
    s_waitcnt lgkmcnt(0)
    s_and_b64 s[20:21], s[20:21], s[22:23]
    s_and_b64 s[20:21], s[20:21], s[24:25]
    s_and_b32 s20, s20, s21
    s_and_b32 s20, s20, s26
    s_cbranch_scc1 K_P_4r
    s_branch K_P_4v
K_P_5s:
    s_load_dwordx8 s[20:27], s[32:33], s50 offset:576
    s_waitcnt lgkmcnt(0)
    s_and_b64 s[20:21], s[20:21], s[22:23]
    s_and_b64 s[20:21], s[20:21], s[24:25]
    s_and_b32 s20, s20, s21
    s_and_b32 s20, s20, s26
    s_cbranch_scc1 K_P_5r
    s_load_dwordx8 s[20:27], s[32:33], s50 offset:640
    s_waitcnt lgkmcnt(0)
    s_and_b64 s[20:21], s[20:21], s[22:23]
    s_and_b64 s[20:21], s[20:21], s[24:25]
    s_and_b32 s20, s20, s21
    s_and_b32 s20, s20, s26
    s_cbranch_scc1 K_P_5r
    s_load_dwordx8 s[20:27], s[32:33], s50 offset:704
    s_waitcnt lgkmcnt(0)
    s_and_b64 s[20:21], s[20:21], s[22:23]
    s_and_b64 s[20:21], s[20:21], s[24:25]
    s_and_b32 s20, s20, s21
    s_and_b32 s20, s20, s26
    s_cbranch_scc1 K_P_5r
    s_branch K_P_5v
K_P_6s:
    s_load_dwordx8 s[20:27], s[32:33], s50 offset:832
    s_waitcnt lgkmcnt(0)
    s_and_b64 s[20:21], s[20:21], s[22:23]
    s_and_b64 s[20:21], s[20:21], s[24:25]
    s_and_b32 s20, s20, s21
    s_and_b32 s20, s20, s26
    s_cbranch_scc1 K_P_6r
    s_load_dwordx8 s[20:27], s[32:33], s50 offset:896
    s_waitcnt lgkmcnt(0)
    s_and_b64 s[20:21], s[20:21], s[22:23]
    s_and_b64 s[20:21], s[20:21], s[24:25]
    s_and_b32 s20, s20, s21
    s_and_b32 s20, s20, s26
    s_cbranch_scc1 K_P_6r
    s_load_dwordx8 s[20:27], s[32:33], s50 offset:960
    s_waitcnt lgkmcnt(0)
    s_and_b64 s[20:21], s[20:21], s[22:23]
    s_and_b64 s[20:21], s[20:21], s[24:25]
    s_and_b32 s20, s20, s21
    s_and_b32 s20, s20, s26
    s_cbranch_scc1 K_P_6r
    s_branch K_P_6v
K_PGA3:
    s_cbranch_execz K_WRA
    s_nop 0
K_PS:
    s_mov_b32 s54, 1048576
    s_mov_b64 exec, 1
K_PS1:
    v_mov_b32 v92, 0
    buffer_atomic_add v92, off, s[36:39], s17 sc0 sc1
    s_sub_u32 s54, s54, 1
    s_cbranch_scc1 K_PS2
    s_waitcnt vmcnt(0)
    v_cmp_gt_u32 vcc, 32, v92
    s_cbranch_vccnz K_PS1
K_PS2:
    s_mov_b64 exec, -1
    s_branch K_PR
K_W3s0:
    s_mov_b32 s54, 1048576
K_W3l0:
    buffer_load_dword v21, off, s[36:39], s19 offset:0 sc1
    s_sub_u32 s54, s54, 1
    s_cbranch_scc1 K_W3r0
    s_waitcnt vmcnt(0)
    v_cmp_gt_u32 vcc, 4, v21
    s_cbranch_vccnz K_W3l0
    s_branch K_W3r0
K_SS0:
    s_mov_b32 s54, 1048576
K_SL0:
    s_sleep 2
    global_load_dwordx4 v[64:67], v80, s[32:33] offset:-4096 sc1
    global_load_dwordx4 v[68:71], v80, s[32:33] offset:0 sc1
    global_load_dwordx4 v[72:75], v81, s[32:33] offset:-4096 sc1
    global_load_dwordx4 v[76:79], v81, s[32:33] offset:0 sc1
    s_sub_u32 s54, s54, 1
    s_cselect_b32 s3, 0, 1
    s_waitcnt vmcnt(0)
    v_min3_u32 v20, v64, v65, v66
    v_min3_u32 v20, v20, v67, v68
    v_min3_u32 v20, v20, v69, v70
    v_min3_u32 v20, v20, v71, v72
    v_min3_u32 v20, v20, v73, v74
    v_min3_u32 v20, v20, v75, v76
    v_min3_u32 v20, v20, v77, v78
    v_min_u32 v20, v20, v79
    v_cmp_gt_u32 vcc, s3, v20
    s_cbranch_vccnz K_SL0
    s_branch K_SR0
K_SS1:
    s_mov_b32 s54, 1048576
K_SL1:
    s_sleep 2
    global_load_dwordx4 v[64:67], v80, s[32:33] offset:-4096 sc1
    global_load_dwordx4 v[68:71], v80, s[32:33] offset:0 sc1
    global_load_dwordx4 v[72:75], v81, s[32:33] offset:-4096 sc1
    global_load_dwordx4 v[76:79], v81, s[32:33] offset:0 sc1
    s_sub_u32 s54, s54, 1
    s_cselect_b32 s3, 0, 1
    s_waitcnt vmcnt(0)
    v_min3_u32 v20, v64, v65, v66
    v_min3_u32 v20, v20, v67, v68
    v_min3_u32 v20, v20, v69, v70
    v_min3_u32 v20, v20, v71, v72
    v_min3_u32 v20, v20, v73, v74
    v_min3_u32 v20, v20, v75, v76
    v_min3_u32 v20, v20, v77, v78
    v_min_u32 v20, v20, v79
    v_cmp_gt_u32 vcc, s3, v20
    s_cbranch_vccnz K_SL1
    s_branch K_SR1
K_ZS:
    s_mov_b32 s54, 1048576
K_ZS1:
    global_load_dword v92, v93, s[30:31] offset:128 sc1
    s_sub_u32 s54, s54, 1
    s_cselect_b32 s3, 0, 1
    s_waitcnt vmcnt(0)
    v_readfirstlane_b32 s4, v92
    s_nop 0
    s_cmp_lt_u32 s4, s3
    s_cbranch_scc1 K_ZS1
    s_branch K_ZR
K_Z2s:
    s_mov_b32 s54, 1048576
K_Z2l:
    global_load_dword v73, v93, s[30:31] sc1
    s_sub_u32 s54, s54, 1
    s_cbranch_scc1 K_Z2r
    s_waitcnt vmcnt(0)
    v_cmp_gt_u32 vcc, 32, v73
    s_cbranch_vccnz K_Z2l
    s_branch K_Z2r
K_W4s:
    s_mov_b32 s54, 1048576
K_W4l:
    buffer_load_dword v25, off, s[36:39], s14 offset:2048 sc1
    s_sub_u32 s54, s54, 1
    s_cbranch_scc1 K_W4r
    s_waitcnt vmcnt(0)
    v_cmp_gt_u32 vcc, 4, v25
    s_cbranch_vccnz K_W4l
    s_branch K_W4r
K_X2s:
    s_mov_b64 exec, 1
    buffer_store_dword v28, off, s[36:39], s56 offset:0 sc1
    s_mov_b64 exec, -1
    s_mov_b32 s54, 1048575
K_X2v:
    s_and_b32 s53, s54, 7
    s_cselect_b32 s53, 0, 196608
    buffer_load_dword v12, v15, s[36:39], s53 offen offset:0 sc1
    s_sub_u32 s54, s54, 1
    s_cselect_b32 s55, 0, 1
    s_waitcnt vmcnt(0)
    v_cmp_gt_u32 vcc, s55, v12
    s_cbranch_vccnz K_X2v
    s_branch K_X2r
K_P_3v:
    v_lshlrev_b32 v27, 8, v1
    s_mov_b64 exec, 1
    buffer_store_dword v28, v27, s[36:39], s59 offen sc1
    s_mov_b64 exec, 1
    buffer_store_dword v28, off, s[36:39], s56 offset:0 sc1
    s_mov_b64 exec, -1
    s_mov_b32 s54, 1048575
K_P_3l:
    s_and_b32 s53, s54, 7
    s_cselect_b32 s53, 0, 196608
    buffer_load_dword v12, v15, s[36:39], s53 offen offset:0 sc1
    s_sub_u32 s54, s54, 1
    s_cselect_b32 s55, 0, 1
    s_waitcnt vmcnt(0)
    v_cmp_gt_u32 vcc, s55, v12
    s_cbranch_vccnz K_P_3l
    s_branch K_P_3r
K_P_4v:
    v_lshlrev_b32 v27, 8, v1
    s_mov_b64 exec, 3
    buffer_store_dword v28, v27, s[36:39], s59 offen sc1
    s_mov_b64 exec, 1
    buffer_store_dword v28, off, s[36:39], s56 offset:0 sc1
    s_mov_b64 exec, -1
    s_mov_b32 s54, 1048575
K_P_4l:
    s_and_b32 s53, s54, 7
    s_cselect_b32 s53, 0, 196608
    buffer_load_dword v12, v15, s[36:39], s53 offen offset:256 sc1
    s_sub_u32 s54, s54, 1
    s_cselect_b32 s55, 0, 1
    s_waitcnt vmcnt(0)
    v_cmp_gt_u32 vcc, s55, v12
    s_cbranch_vccnz K_P_4l
    s_branch K_P_4r
K_P_5v:
    v_lshlrev_b32 v27, 8, v1
    s_mov_b64 exec, 7
    buffer_store_dword v28, v27, s[36:39], s59 offen sc1
    s_mov_b64 exec, 1
    buffer_store_dword v28, off, s[36:39], s56 offset:0 sc1
    s_mov_b64 exec, -1
    s_mov_b32 s54, 1048575
K_P_5l:
    s_and_b32 s53, s54, 7
    s_cselect_b32 s53, 0, 196608
    buffer_load_dword v12, v15, s[36:39], s53 offen offset:512 sc1
    s_sub_u32 s54, s54, 1
    s_cselect_b32 s55, 0, 1
    s_waitcnt vmcnt(0)
    v_cmp_gt_u32 vcc, s55, v12
    s_cbranch_vccnz K_P_5l
    s_branch K_P_5r
K_P_6v:
    v_lshlrev_b32 v27, 8, v1
    s_mov_b64 exec, 15
    buffer_store_dword v28, v27, s[36:39], s59 offen sc1
    s_mov_b64 exec, 1
    buffer_store_dword v28, off, s[36:39], s56 offset:0 sc1
    s_mov_b64 exec, -1
    s_mov_b32 s54, 1048575
K_P_6l:
    s_and_b32 s53, s54, 7
    s_cselect_b32 s53, 0, 196608
    buffer_load_dword v12, v15, s[36:39], s53 offen offset:768 sc1
    s_sub_u32 s54, s54, 1
    s_cselect_b32 s55, 0, 1
    s_waitcnt vmcnt(0)
    v_cmp_gt_u32 vcc, s55, v12
    s_cbranch_vccnz K_P_6l
    s_branch K_P_6r
K_LN:
    v_lshrrev_b32 v2, 6, v0
    v_and_b32 v1, 63, v0
    v_readfirstlane_b32 s34, v2
    s_mov_b32 s38, 19849216
    s_mov_b32 s39, 0x20000
    s_and_b32 s44, s2, 7
    v_lshrrev_b32 v7, 3, v1
    v_and_b32 v17, 7, v1
    v_lshlrev_b32 v9, 4, v17
    v_mul_u32_u24 v16, 896, v7
    s_lshr_b32 s3, s2, 3
    s_lshl_b32 s42, s44, 2
    s_add_u32 s42, s42, s3
    s_lshl_b32 s3, s42, 2
    s_add_u32 s3, s3, s34
    s_mul_i32 s3, s3, 14336
    v_add3_u32 v74, v9, v16, s3
    v_add_u32 v75, 7168, v74
    s_lshl_b32 s52, s42, 7
    s_lshl_b32 s55, s2, 11
    s_add_u32 s55, s55, 65536
    s_cmp_lg_u32 s34, 0
    s_cselect_b32 s52, 2130706432, s52
    s_cselect_b32 s55, 2130706432, s55
    s_lshl_b32 s54, s34, 8
    s_or_b32 s54, s54, s2
    s_cmp_eq_u32 s54, 287
    s_cselect_b32 s55, 32768, s55
    v_mov_b32 v76, v7
    v_lshl_add_u32 v77, v7, 12, v9
    v_mov_b32 v78, v17
    v_lshl_add_u32 v79, v7, 8, v9
    v_mov_b32 v12, 0
    v_mov_b32 v13, 0
    v_mov_b32 v14, 0
    v_mov_b32 v15, 0
    v_mov_b32 v72, 1
    s_waitcnt lgkmcnt(0)
    s_mov_b32 s36, s32
    s_mov_b32 s37, s33
    buffer_store_dwordx4 v[12:15], v79, s[36:39], s55 offen sc1
    buffer_store_dwordx4 v[12:15], v77, s[36:39], s52 offen sc1
    global_load_dwordx4 v[16:19], v74, s[4:5] offset:0
    global_load_dwordx4 v[20:23], v74, s[4:5] offset:128
    global_load_dwordx4 v[24:27], v74, s[4:5] offset:256
    global_load_dwordx4 v[28:31], v74, s[4:5] offset:384
    global_load_dwordx4 v[32:35], v74, s[4:5] offset:512
    global_load_dwordx4 v[36:39], v74, s[4:5] offset:640
    global_load_dwordx4 v[40:43], v74, s[4:5] offset:768
    s_cbranch_scc0 K_NZ
    s_mov_b64 exec, 1
    s_waitcnt vmcnt(7)
    global_store_dword v12, v72, s[30:31] offset:128 sc1
    s_mov_b64 exec, -1
K_NZ:
    global_load_dwordx4 v[44:47], v75, s[4:5] offset:0
    global_load_dwordx4 v[48:51], v75, s[4:5] offset:128
    global_load_dwordx4 v[52:55], v75, s[4:5] offset:256
    global_load_dwordx4 v[56:59], v75, s[4:5] offset:384
    global_load_dwordx4 v[60:63], v75, s[4:5] offset:512
    global_load_dwordx4 v[64:67], v75, s[4:5] offset:640
    global_load_dwordx4 v[68:71], v75, s[4:5] offset:768
    s_mov_b32 s48, 0x3f803f80
    s_cmp_lg_u32 s34, 0
    s_cbranch_scc1 K_LN1
    v_mov_b32 v72, 1
    s_waitcnt vmcnt(14)
    s_mov_b64 exec, 1
    global_atomic_add v12, v72, s[30:31] sc1
    s_mov_b64 exec, -1
K_LN1:
    s_mul_i32 s56, s34, 14336
    s_cmp_lg_u32 s34, 0
    s_cselect_b32 s57, 2130706432, 0
    s_sub_u32 s5, s2, 28
    s_mul_i32 s8, s2, 57344
    s_lshr_b32 s9, s56, 1
    s_add_u32 s8, s8, s9
    s_add_u32 s8, s8, 6815744
    s_lshr_b32 s51, s2, 2
    s_lshl_b32 s51, s51, 7
    s_add_u32 s51, s51, 24576
    s_max_u32 s51, s51, s57
    s_lshl_b32 s49, s2, 8
    s_add_u32 s49, s49, 262144
    s_max_u32 s49, s49, s57
    s_cmp_lt_u32 s2, 28
    s_cselect_b64 s[40:41], s[24:25], s[20:21]
    s_cselect_b32 s6, s2, s5
    s_cselect_b32 s7, 4, 1
    s_cselect_b32 s43, s8, 2130706432
    s_mul_i32 s7, s7, 896
    s_movk_i32 s46, 1024
    s_movk_i32 s47, 28672
    s_lshl_b32 s42, s7, 3
    s_sub_u32 s42, s42, 1024
    s_mul_i32 s8, s7, 112
    s_mul_i32 s8, s8, s34
    s_lshl_b32 s6, s6, 7
    s_add_u32 s8, s8, s6
    v_lshrrev_b32 v91, 2, v1
    v_and_b32 v91, 4, v91
    v_xor_b32 v91, v91, v78
    v_lshlrev_b32 v91, 4, v91
    v_mul_u32_u24 v90, s7, v76
    v_add3_u32 v90, v90, v91, s8
    s_mov_b64 exec, 0
    s_cmp_eq_u32 s34, 0
    s_cbranch_scc1 K_PGC0
    s_cmp_eq_u32 s34, 1
    s_cbranch_scc1 K_WRC
    s_cmp_eq_u32 s34, 2
    s_cbranch_scc1 K_WRC
    s_cmp_eq_u32 s34, 3
    s_cbranch_scc1 K_WRC
K_WRC:
    s_mov_b64 exec, -1
    s_barrier
    s_waitcnt vmcnt(13)
    v_dot2_f32_bf16 v8, v16, s48, 0
    v_dot2_f32_bf16 v10, v16, v16, 0
    v_dot2_f32_bf16 v8, v17, s48, v8
    v_dot2_f32_bf16 v10, v17, v17, v10
    v_dot2_f32_bf16 v8, v18, s48, v8
    v_dot2_f32_bf16 v10, v18, v18, v10
    v_dot2_f32_bf16 v8, v19, s48, v8
    v_dot2_f32_bf16 v10, v19, v19, v10
    s_waitcnt vmcnt(12)
    s_nop 0
    v_dot2_f32_bf16 v8, v20, s48, v8
    v_dot2_f32_bf16 v10, v20, v20, v10
    v_dot2_f32_bf16 v8, v21, s48, v8
    v_dot2_f32_bf16 v10, v21, v21, v10
    v_dot2_f32_bf16 v8, v22, s48, v8
    v_dot2_f32_bf16 v10, v22, v22, v10
    v_dot2_f32_bf16 v8, v23, s48, v8
    v_dot2_f32_bf16 v10, v23, v23, v10
    s_waitcnt vmcnt(11)
    s_nop 0
    v_dot2_f32_bf16 v8, v24, s48, v8
    v_dot2_f32_bf16 v10, v24, v24, v10
    v_dot2_f32_bf16 v8, v25, s48, v8
    v_dot2_f32_bf16 v10, v25, v25, v10
    v_dot2_f32_bf16 v8, v26, s48, v8
    v_dot2_f32_bf16 v10, v26, v26, v10
    v_dot2_f32_bf16 v8, v27, s48, v8
    v_dot2_f32_bf16 v10, v27, v27, v10
    s_waitcnt vmcnt(10)
    s_nop 0
    v_dot2_f32_bf16 v8, v28, s48, v8
    v_dot2_f32_bf16 v10, v28, v28, v10
    v_dot2_f32_bf16 v8, v29, s48, v8
    v_dot2_f32_bf16 v10, v29, v29, v10
    v_dot2_f32_bf16 v8, v30, s48, v8
    v_dot2_f32_bf16 v10, v30, v30, v10
    v_dot2_f32_bf16 v8, v31, s48, v8
    v_dot2_f32_bf16 v10, v31, v31, v10
    s_waitcnt vmcnt(9)
    s_nop 0
    v_dot2_f32_bf16 v8, v32, s48, v8
    v_dot2_f32_bf16 v10, v32, v32, v10
    v_dot2_f32_bf16 v8, v33, s48, v8
    v_dot2_f32_bf16 v10, v33, v33, v10
    v_dot2_f32_bf16 v8, v34, s48, v8
    v_dot2_f32_bf16 v10, v34, v34, v10
    v_dot2_f32_bf16 v8, v35, s48, v8
    v_dot2_f32_bf16 v10, v35, v35, v10
    s_waitcnt vmcnt(8)
    s_nop 0
    v_dot2_f32_bf16 v8, v36, s48, v8
    v_dot2_f32_bf16 v10, v36, v36, v10
    v_dot2_f32_bf16 v8, v37, s48, v8
    v_dot2_f32_bf16 v10, v37, v37, v10
    v_dot2_f32_bf16 v8, v38, s48, v8
    v_dot2_f32_bf16 v10, v38, v38, v10
    v_dot2_f32_bf16 v8, v39, s48, v8
    v_dot2_f32_bf16 v10, v39, v39, v10
    s_waitcnt vmcnt(7)
    s_nop 0
    v_dot2_f32_bf16 v8, v40, s48, v8
    v_dot2_f32_bf16 v10, v40, v40, v10
    v_dot2_f32_bf16 v8, v41, s48, v8
    v_dot2_f32_bf16 v10, v41, v41, v10
    v_dot2_f32_bf16 v8, v42, s48, v8
    v_dot2_f32_bf16 v10, v42, v42, v10
    v_dot2_f32_bf16 v8, v43, s48, v8
    v_dot2_f32_bf16 v10, v43, v43, v10
    s_waitcnt vmcnt(6)
    s_nop 0
    v_dot2_f32_bf16 v9, v44, s48, 0
    v_dot2_f32_bf16 v11, v44, v44, 0
    v_dot2_f32_bf16 v9, v45, s48, v9
    v_dot2_f32_bf16 v11, v45, v45, v11
    v_dot2_f32_bf16 v9, v46, s48, v9
    v_dot2_f32_bf16 v11, v46, v46, v11
    v_dot2_f32_bf16 v9, v47, s48, v9
    v_dot2_f32_bf16 v11, v47, v47, v11
    s_waitcnt vmcnt(5)
    s_nop 0
    v_dot2_f32_bf16 v9, v48, s48, v9
    v_dot2_f32_bf16 v11, v48, v48, v11
    v_dot2_f32_bf16 v9, v49, s48, v9
    v_dot2_f32_bf16 v11, v49, v49, v11
    v_dot2_f32_bf16 v9, v50, s48, v9
    v_dot2_f32_bf16 v11, v50, v50, v11
    v_dot2_f32_bf16 v9, v51, s48, v9
    v_dot2_f32_bf16 v11, v51, v51, v11
    s_waitcnt vmcnt(4)
    s_nop 0
    v_dot2_f32_bf16 v9, v52, s48, v9
    v_dot2_f32_bf16 v11, v52, v52, v11
    v_dot2_f32_bf16 v9, v53, s48, v9
    v_dot2_f32_bf16 v11, v53, v53, v11
    v_dot2_f32_bf16 v9, v54, s48, v9
    v_dot2_f32_bf16 v11, v54, v54, v11
    v_dot2_f32_bf16 v9, v55, s48, v9
    v_dot2_f32_bf16 v11, v55, v55, v11
K_PGC0:
    s_cbranch_execz K_WRC
    s_nop 0
    s_waitcnt vmcnt(3)
    s_nop 0
    v_dot2_f32_bf16 v9, v56, s48, v9
    v_dot2_f32_bf16 v11, v56, v56, v11
    v_dot2_f32_bf16 v9, v57, s48, v9
    v_dot2_f32_bf16 v11, v57, v57, v11
    v_dot2_f32_bf16 v9, v58, s48, v9
    v_dot2_f32_bf16 v11, v58, v58, v11
    v_dot2_f32_bf16 v9, v59, s48, v9
    v_dot2_f32_bf16 v11, v59, v59, v11
    s_waitcnt vmcnt(2)
    s_nop 0
    v_dot2_f32_bf16 v9, v60, s48, v9
    v_dot2_f32_bf16 v11, v60, v60, v11
    v_dot2_f32_bf16 v9, v61, s48, v9
    v_dot2_f32_bf16 v11, v61, v61, v11
    v_dot2_f32_bf16 v9, v62, s48, v9
    v_dot2_f32_bf16 v11, v62, v62, v11
    v_dot2_f32_bf16 v9, v63, s48, v9
    v_dot2_f32_bf16 v11, v63, v63, v11
    s_waitcnt vmcnt(1)
    s_nop 0
    v_dot2_f32_bf16 v9, v64, s48, v9
    v_dot2_f32_bf16 v11, v64, v64, v11
    v_dot2_f32_bf16 v9, v65, s48, v9
    v_dot2_f32_bf16 v11, v65, v65, v11
    v_dot2_f32_bf16 v9, v66, s48, v9
    v_dot2_f32_bf16 v11, v66, v66, v11
    v_dot2_f32_bf16 v9, v67, s48, v9
    v_dot2_f32_bf16 v11, v67, v67, v11
    s_waitcnt vmcnt(0)
    s_nop 0
    v_dot2_f32_bf16 v9, v68, s48, v9
    v_dot2_f32_bf16 v11, v68, v68, v11
    v_dot2_f32_bf16 v9, v69, s48, v9
    v_dot2_f32_bf16 v11, v69, v69, v11
    v_dot2_f32_bf16 v9, v70, s48, v9
    v_dot2_f32_bf16 v11, v70, v70, v11
    v_dot2_f32_bf16 v9, v71, s48, v9
    v_dot2_f32_bf16 v11, v71, v71, v11
    v_add_f32_dpp v8, v8, v8 quad_perm:[1,0,3,2] row_mask:0xf bank_mask:0xf
    s_nop 0
    s_nop 0
    v_add_f32_dpp v9, v9, v9 quad_perm:[1,0,3,2] row_mask:0xf bank_mask:0xf
    v_add_f32_dpp v10, v10, v10 quad_perm:[1,0,3,2] row_mask:0xf bank_mask:0xf
    v_add_f32_dpp v11, v11, v11 quad_perm:[1,0,3,2] row_mask:0xf bank_mask:0xf
    v_add_f32_dpp v8, v8, v8 quad_perm:[2,3,0,1] row_mask:0xf bank_mask:0xf
    v_add_f32_dpp v9, v9, v9 quad_perm:[2,3,0,1] row_mask:0xf bank_mask:0xf
    v_add_f32_dpp v10, v10, v10 quad_perm:[2,3,0,1] row_mask:0xf bank_mask:0xf
    v_add_f32_dpp v11, v11, v11 quad_perm:[2,3,0,1] row_mask:0xf bank_mask:0xf
    v_add_f32_dpp v8, v8, v8 row_half_mirror row_mask:0xf bank_mask:0xf
    v_add_f32_dpp v9, v9, v9 row_half_mirror row_mask:0xf bank_mask:0xf
    v_add_f32_dpp v10, v10, v10 row_half_mirror row_mask:0xf bank_mask:0xf
    v_add_f32_dpp v11, v11, v11 row_half_mirror row_mask:0xf bank_mask:0xf
    v_mul_f32 v8, 0x3b124925, v8
    v_mul_f32 v9, 0x3b124925, v9
    v_mul_f32 v10, 0x3b124925, v10
    v_mul_f32 v11, 0x3b124925, v11
    v_fma_f32 v10, -v8, v8, v10
    v_fma_f32 v11, -v9, v9, v11
    v_max_f32 v10, 0, v10
    v_max_f32 v11, 0, v11
    v_add_f32 v10, 0x3727c5ac, v10
    v_add_f32 v11, 0x3727c5ac, v11
    v_rsq_f32 v10, v10
    v_rsq_f32 v11, v11
    v_mul_f32_e64 v8, -v8, v10
    v_mul_f32_e64 v9, -v9, v11
    v_or_b32 v8, 1, v8
    v_or_b32 v9, 1, v9
    v_or_b32 v10, 1, v10
    v_or_b32 v11, 1, v11
    v_lshrrev_b32 v3, 1, v76
    v_lshlrev_b32 v3, 7, v3
    v_and_b32 v5, 1, v76
    v_lshl_add_u32 v3, v5, 2, v3
    s_lshl_b32 s3, s34, 5
    v_add_u32 v3, s3, v3
    ds_write2_b32 v3, v10, v8 offset0:0 offset1:2
    ds_write2_b32 v3, v11, v9 offset0:4 offset1:6
    s_waitcnt lgkmcnt(0)
    s_barrier
    s_cmp_lg_u32 s34, 0
    s_cbranch_scc1 K_LN2
    v_and_b32 v3, 31, v1
    v_lshlrev_b32 v5, 4, v3
    ds_read_b128 v[12:15], v5
    s_mov_b32 exec_hi, 0
    s_waitcnt lgkmcnt(0)
    buffer_store_dwordx4 v[12:15], v77, s[36:39], s52 offen sc1
    s_mov_b64 exec, -1
K_LN2:
    s_add_u32 m0, s56, 4096
    s_nop 0
    global_load_lds_dwordx4 v90, s[40:41] offset:0
    v_add_u32 v90, s42, v90
    global_load_lds_dwordx4 v90, s[40:41] offset:1024
    v_add_u32 v90, s42, v90
    global_load_lds_dwordx4 v90, s[40:41] offset:2048
    v_add_u32 v90, s42, v90
    global_load_lds_dwordx4 v90, s[40:41] offset:3072
    v_add_u32 v90, s42, v90
    v_add_u32 v90, 4096, v90
    s_add_u32 m0, s56, 8192
    s_nop 0
    global_load_lds_dwordx4 v90, s[40:41] offset:0
    v_add_u32 v90, s42, v90
    global_load_lds_dwordx4 v90, s[40:41] offset:1024
    v_add_u32 v90, s42, v90
    global_load_lds_dwordx4 v90, s[40:41] offset:2048
    v_add_u32 v90, s42, v90
    global_load_lds_dwordx4 v90, s[40:41] offset:3072
    v_add_u32 v90, s42, v90
    v_add_u32 v90, 4096, v90
    s_add_u32 m0, s56, 12288
    s_nop 0
    global_load_lds_dwordx4 v90, s[40:41] offset:0
    v_add_u32 v90, s42, v90
    global_load_lds_dwordx4 v90, s[40:41] offset:1024
    v_add_u32 v90, s42, v90
    global_load_lds_dwordx4 v90, s[40:41] offset:2048
    v_add_u32 v90, s42, v90
    global_load_lds_dwordx4 v90, s[40:41] offset:3072
    v_add_u32 v90, s42, v90
    v_add_u32 v90, 4096, v90
    s_add_u32 m0, s56, 16384
    s_nop 0
    global_load_lds_dwordx4 v90, s[40:41] offset:0
    v_add_u32 v90, s42, v90
    global_load_lds_dwordx4 v90, s[40:41] offset:1024
    v_lshrrev_b32 v84, 5, v1
    v_lshlrev_b32 v84, 9, v84
    v_bfe_u32 v85, v1, 2, 2
    v_lshl_add_u32 v84, v85, 7, v84
    v_bfe_u32 v85, v1, 3, 1
    v_lshl_add_u32 v84, v85, 6, v84
    v_bfe_u32 v85, v1, 4, 1
    v_lshl_add_u32 v84, v85, 5, v84
    v_and_b32 v85, 3, v1
    v_lshl_add_u32 v84, v85, 3, v84
    s_add_u32 s3, s56, 4096
    v_add_u32 v84, s3, v84
    v_xor_b32 v85, 64, v84
    v_lshlrev_b32 v86, 4, v1
    v_lshlrev_b32 v87, 2, v0
    v_lshlrev_b32 v88, 2, v1
    v_mov_b32 v89, 0
    v_mov_b32 v72, 1
    global_load_dword v3, v89, s[30:31] sc1
    s_add_u32 s58, s43, s47
    s_waitcnt vmcnt(13)
    ds_read_b64_tr_b16 v[96:97], v84 offset:0
    ds_read_b64_tr_b16 v[98:99], v84 offset:1024
    ds_read_b64_tr_b16 v[100:101], v85 offset:0
    ds_read_b64_tr_b16 v[102:103], v85 offset:1024
    s_waitcnt vmcnt(11)
    ds_read_b64_tr_b16 v[104:105], v84 offset:2048
    ds_read_b64_tr_b16 v[106:107], v84 offset:3072
    ds_read_b64_tr_b16 v[108:109], v85 offset:2048
    ds_read_b64_tr_b16 v[110:111], v85 offset:3072
    s_waitcnt lgkmcnt(4)
    buffer_store_dwordx4 v[96:99], v86, s[36:39], s43 offen sc1
    s_add_u32 s43, s43, s46
    s_waitcnt vmcnt(10)
    ds_read_b64_tr_b16 v[112:113], v84 offset:4096
    ds_read_b64_tr_b16 v[114:115], v84 offset:5120
    ds_read_b64_tr_b16 v[116:117], v85 offset:4096
    ds_read_b64_tr_b16 v[118:119], v85 offset:5120
    s_waitcnt lgkmcnt(4)
    buffer_store_dwordx4 v[104:107], v86, s[36:39], s43 offen sc1
    s_add_u32 s43, s43, s46
    s_waitcnt vmcnt(9)
    ds_read_b64_tr_b16 v[120:121], v84 offset:6144
    ds_read_b64_tr_b16 v[122:123], v84 offset:7168
    ds_read_b64_tr_b16 v[124:125], v85 offset:6144
    ds_read_b64_tr_b16 v[126:127], v85 offset:7168
    s_waitcnt lgkmcnt(4)
    buffer_store_dwordx4 v[112:115], v86, s[36:39], s43 offen sc1
    s_add_u32 s43, s43, s46
    s_waitcnt vmcnt(8)
    ds_read_b64_tr_b16 v[128:129], v84 offset:8192
    ds_read_b64_tr_b16 v[130:131], v84 offset:9216
    ds_read_b64_tr_b16 v[132:133], v85 offset:8192
    ds_read_b64_tr_b16 v[134:135], v85 offset:9216
    s_waitcnt lgkmcnt(4)
    buffer_store_dwordx4 v[120:123], v86, s[36:39], s43 offen sc1
    s_add_u32 s43, s43, s46
    s_waitcnt vmcnt(7)
    ds_read_b64_tr_b16 v[136:137], v84 offset:10240
    ds_read_b64_tr_b16 v[138:139], v84 offset:11264
    ds_read_b64_tr_b16 v[140:141], v85 offset:10240
    ds_read_b64_tr_b16 v[142:143], v85 offset:11264
    s_waitcnt lgkmcnt(4)
    buffer_store_dwordx4 v[128:131], v86, s[36:39], s43 offen sc1
    s_add_u32 s43, s43, s46
    s_waitcnt vmcnt(6)
    ds_read_b64_tr_b16 v[144:145], v84 offset:12288
    ds_read_b64_tr_b16 v[146:147], v84 offset:13312
    ds_read_b64_tr_b16 v[148:149], v85 offset:12288
    ds_read_b64_tr_b16 v[150:151], v85 offset:13312
    s_waitcnt lgkmcnt(4)
    buffer_store_dwordx4 v[136:139], v86, s[36:39], s43 offen sc1
    s_add_u32 s43, s43, s46
    s_waitcnt lgkmcnt(0)
    buffer_store_dwordx4 v[144:147], v86, s[36:39], s43 offen sc1
    s_add_u32 s43, s43, s46
    s_waitcnt vmcnt(0)
    v_cmp_gt_u32 vcc, 32, v3
    s_cbranch_vccnz K_WZ
K_WZ1:
    s_barrier
    s_mov_b64 exec, 1
    buffer_atomic_add v72, off, s[36:39], s51 sc1
    s_mov_b64 exec, -1
    buffer_store_dwordx4 v[100:103], v86, s[36:39], s58 offen sc1
    s_add_u32 s58, s58, s46
    buffer_store_dwordx4 v[108:111], v86, s[36:39], s58 offen sc1
    s_add_u32 s58, s58, s46
    buffer_store_dwordx4 v[116:119], v86, s[36:39], s58 offen sc1
    s_add_u32 s58, s58, s46
    buffer_store_dwordx4 v[124:127], v86, s[36:39], s58 offen sc1
    s_add_u32 s58, s58, s46
    buffer_store_dwordx4 v[132:135], v86, s[36:39], s58 offen sc1
    s_add_u32 s58, s58, s46
    buffer_store_dwordx4 v[140:143], v86, s[36:39], s58 offen sc1
    s_add_u32 s58, s58, s46
    buffer_store_dwordx4 v[148:151], v86, s[36:39], s58 offen sc1
    s_add_u32 s58, s58, s46
    s_mov_b32 s50, s49
    s_sub_u32 s5, s2, 24
    s_min_u32 s5, s5, 6
    s_lshr_b32 s6, s2, 2
    s_and_b32 s7, s2, 3
    s_mul_i32 s8, s2, 57344
    s_add_u32 s8, s8, s56
    s_add_u32 s8, s8, 8421376
    s_lshl_b32 s9, s5, 8
    s_add_u32 s9, s9, 269312
    s_cmp_lt_u32 s2, 28
    s_cselect_b64 s[40:41], s[26:27], s[20:21]
    s_cselect_b32 s6, s6, s5
    s_cselect_b32 s7, s7, 0
    s_cselect_b32 s43, s8, 2130706432
    s_cselect_b32 s49, 2130706432, s9
    s_max_u32 s49, s49, s57
    s_movk_i32 s46, 2048
    s_movk_i32 s47, 1024
    s_lshl_b32 s7, s7, 2
    s_add_u32 s7, s7, s34
    s_mul_i32 s7, s7, 100352
    s_lshl_b32 s6, s6, 7
    s_add_u32 s7, s7, s6
    v_mul_u32_u24 v90, 896, v76
    v_add3_u32 v90, v90, v91, s7
    s_movk_i32 s42, 6144
    v_add_u32 v84, 57344, v84
    v_add_u32 v85, 57344, v85
    s_add_u32 m0, s56, 61440
    s_nop 0
    global_load_lds_dwordx4 v90, s[40:41] offset:0
    v_add_u32 v90, s42, v90
    global_load_lds_dwordx4 v90, s[40:41] offset:1024
    v_add_u32 v90, s42, v90
    global_load_lds_dwordx4 v90, s[40:41] offset:2048
    v_add_u32 v90, s42, v90
    global_load_lds_dwordx4 v90, s[40:41] offset:3072
    v_add_u32 v90, s42, v90
    v_add_u32 v90, 4096, v90
    s_add_u32 m0, s56, 65536
    s_nop 0
    global_load_lds_dwordx4 v90, s[40:41] offset:0
    v_add_u32 v90, s42, v90
    global_load_lds_dwordx4 v90, s[40:41] offset:1024
    v_add_u32_e64 v90, s42, v90
    v_dot2_f32_bf16 v92, v96, s48, 0
    v_dot2_f32_bf16 v93, v100, s48, 0
    v_dot2_f32_bf16 v92, v97, s48, v92
    v_dot2_f32_bf16 v93, v101, s48, v93
    v_dot2_f32_bf16 v92, v98, s48, v92
    v_dot2_f32_bf16 v93, v102, s48, v93
    v_dot2_f32_bf16 v92, v99, s48, v92
    v_dot2_f32_bf16 v93, v103, s48, v93
    v_dot2_f32_bf16 v92, v104, s48, v92
    v_dot2_f32_bf16 v93, v108, s48, v93
    v_dot2_f32_bf16 v92, v105, s48, v92
    v_dot2_f32_bf16 v93, v109, s48, v93
    v_dot2_f32_bf16 v92, v106, s48, v92
    v_dot2_f32_bf16 v93, v110, s48, v93
    v_dot2_f32_bf16 v92, v107, s48, v92
    v_dot2_f32_bf16 v93, v111, s48, v93
    v_dot2_f32_bf16 v92, v112, s48, v92
    v_dot2_f32_bf16 v93, v116, s48, v93
    v_dot2_f32_bf16 v92, v113, s48, v92
    v_dot2_f32_bf16 v93, v117, s48, v93
    v_dot2_f32_bf16 v92, v114, s48, v92
    v_dot2_f32_bf16 v93, v118, s48, v93
    v_dot2_f32_bf16 v92, v115, s48, v92
    v_dot2_f32_bf16 v93, v119, s48, v93
    v_dot2_f32_bf16 v92, v120, s48, v92
    v_dot2_f32_bf16 v93, v124, s48, v93
    v_dot2_f32_bf16 v92, v121, s48, v92
    v_dot2_f32_bf16 v93, v125, s48, v93
    v_dot2_f32_bf16 v92, v122, s48, v92
    v_dot2_f32_bf16 v93, v126, s48, v93
    v_dot2_f32_bf16 v92, v123, s48, v92
    v_dot2_f32_bf16 v93, v127, s48, v93
    v_dot2_f32_bf16 v92, v128, s48, v92
    v_dot2_f32_bf16 v93, v132, s48, v93
    v_dot2_f32_bf16 v92, v129, s48, v92
    v_dot2_f32_bf16 v93, v133, s48, v93
    v_dot2_f32_bf16 v92, v130, s48, v92
    v_dot2_f32_bf16 v93, v134, s48, v93
    v_dot2_f32_bf16 v92, v131, s48, v92
    v_dot2_f32_bf16 v93, v135, s48, v93
    v_dot2_f32_bf16 v92, v136, s48, v92
    v_dot2_f32_bf16 v93, v140, s48, v93
    v_dot2_f32_bf16 v92, v137, s48, v92
    v_dot2_f32_bf16 v93, v141, s48, v93
    v_dot2_f32_bf16 v92, v138, s48, v92
    v_dot2_f32_bf16 v93, v142, s48, v93
    v_dot2_f32_bf16 v92, v139, s48, v92
    v_dot2_f32_bf16 v93, v143, s48, v93
    v_dot2_f32_bf16 v92, v144, s48, v92
    v_dot2_f32_bf16 v93, v148, s48, v93
    v_dot2_f32_bf16 v92, v145, s48, v92
    v_dot2_f32_bf16 v93, v149, s48, v93
    v_dot2_f32_bf16 v92, v146, s48, v92
    v_dot2_f32_bf16 v93, v150, s48, v93
    v_dot2_f32_bf16 v92, v147, s48, v92
    v_dot2_f32_bf16 v93, v151, s48, v93
    s_nop 2
    v_permlane32_swap_b32 v92, v93
    v_add_f32 v92, v92, v93
    ds_write_b32 v87, v92 offset:1024
    s_waitcnt vmcnt(6) lgkmcnt(0)
    s_barrier
    s_mov_b64 exec, 1
    buffer_atomic_add v72, off, s[36:39], s51 offset:1024 sc1
    s_mov_b64 exec, -1
    ds_read2st64_b32 v[92:93], v88 offset0:4 offset1:5
    ds_read2st64_b32 v[94:95], v88 offset0:6 offset1:7
    s_waitcnt lgkmcnt(0)
    v_add_f32 v92, v92, v93
    v_add_f32 v94, v94, v95
    v_add_f32 v92, v92, v94
    buffer_store_dword v92, v88, s[36:39], s50 offen sc1
    s_lshl_b32 s3, s2, 2
    s_add_u32 s3, s3, s34
    s_mul_i32 s3, s3, 3072
    s_add_u32 s3, s3, 19456000
    v_mov_b32 v12, 0
    v_mov_b32 v13, 0
    v_mov_b32 v14, 0
    v_mov_b32 v15, 0
    buffer_store_dwordx4 v[12:15], v86, s[36:39], s3 offen sc1
    buffer_store_dwordx4 v[12:15], v86, s[36:39], s3 offen offset:1024 sc1
    buffer_store_dwordx4 v[12:15], v86, s[36:39], s3 offen offset:2048 sc1
    global_load_lds_dwordx4 v90, s[40:41] offset:2048
    v_add_u32 v90, s42, v90
    global_load_lds_dwordx4 v90, s[40:41] offset:3072
    v_add_u32 v90, s42, v90
    v_add_u32 v90, 4096, v90
    s_add_u32 m0, s56, 69632
    s_nop 0
    global_load_lds_dwordx4 v90, s[40:41] offset:0
    v_add_u32 v90, s42, v90
    global_load_lds_dwordx4 v90, s[40:41] offset:1024
    v_add_u32 v90, s42, v90
    global_load_lds_dwordx4 v90, s[40:41] offset:2048
    v_add_u32 v90, s42, v90
    global_load_lds_dwordx4 v90, s[40:41] offset:3072
    v_add_u32 v90, s42, v90
    v_add_u32 v90, 4096, v90
    s_add_u32 m0, s56, 73728
    s_nop 0
    global_load_lds_dwordx4 v90, s[40:41] offset:0
    v_add_u32 v90, s42, v90
    global_load_lds_dwordx4 v90, s[40:41] offset:1024
    s_lshl_b32 s3, s44, 8
    s_add_u32 s3, s3, 65536
    s_max_u32 s3, s3, s57
    s_cmp_lt_u32 s2, 28
    s_cselect_b32 s10, s3, 2130706432
    s_cselect_b32 s11, 2130706432, s3
    v_lshlrev_b32 v3, 11, v1
    s_waitcnt vmcnt(8)
    s_barrier
    s_mov_b32 exec_hi, 0
    buffer_atomic_add v72, v3, s[36:39], s10 offen sc1
    s_mov_b64 exec, -1
    s_add_u32 s58, s43, s47
    s_waitcnt vmcnt(18)
    ds_read_b64_tr_b16 v[96:97], v84 offset:0
    ds_read_b64_tr_b16 v[98:99], v84 offset:1024
    ds_read_b64_tr_b16 v[100:101], v85 offset:0
    ds_read_b64_tr_b16 v[102:103], v85 offset:1024
    s_waitcnt vmcnt(16)
    ds_read_b64_tr_b16 v[104:105], v84 offset:2048
    ds_read_b64_tr_b16 v[106:107], v84 offset:3072
    ds_read_b64_tr_b16 v[108:109], v85 offset:2048
    ds_read_b64_tr_b16 v[110:111], v85 offset:3072
    s_waitcnt lgkmcnt(4)
    buffer_store_dwordx4 v[96:99], v86, s[36:39], s43 offen sc1
    s_add_u32 s43, s43, s46
    buffer_store_dwordx4 v[100:103], v86, s[36:39], s58 offen sc1
    s_add_u32 s58, s58, s46
    s_waitcnt vmcnt(16)
    ds_read_b64_tr_b16 v[112:113], v84 offset:4096
    ds_read_b64_tr_b16 v[114:115], v84 offset:5120
    ds_read_b64_tr_b16 v[116:117], v85 offset:4096
    ds_read_b64_tr_b16 v[118:119], v85 offset:5120
    s_waitcnt lgkmcnt(4)
    buffer_store_dwordx4 v[104:107], v86, s[36:39], s43 offen sc1
    s_add_u32 s43, s43, s46
    buffer_store_dwordx4 v[108:111], v86, s[36:39], s58 offen sc1
    s_add_u32 s58, s58, s46
    s_waitcnt vmcnt(11)
    ds_read_b64_tr_b16 v[120:121], v84 offset:6144
    ds_read_b64_tr_b16 v[122:123], v84 offset:7168
    ds_read_b64_tr_b16 v[124:125], v85 offset:6144
    ds_read_b64_tr_b16 v[126:127], v85 offset:7168
    s_waitcnt lgkmcnt(4)
    buffer_store_dwordx4 v[112:115], v86, s[36:39], s43 offen sc1
    s_add_u32 s43, s43, s46
    buffer_store_dwordx4 v[116:119], v86, s[36:39], s58 offen sc1
    s_add_u32 s58, s58, s46
    s_waitcnt vmcnt(11)
    ds_read_b64_tr_b16 v[128:129], v84 offset:8192
    ds_read_b64_tr_b16 v[130:131], v84 offset:9216
    ds_read_b64_tr_b16 v[132:133], v85 offset:8192
    ds_read_b64_tr_b16 v[134:135], v85 offset:9216
    s_waitcnt lgkmcnt(4)
    buffer_store_dwordx4 v[120:123], v86, s[36:39], s43 offen sc1
    s_add_u32 s43, s43, s46
    buffer_store_dwordx4 v[124:127], v86, s[36:39], s58 offen sc1
    s_add_u32 s58, s58, s46
    s_waitcnt vmcnt(11)
    ds_read_b64_tr_b16 v[136:137], v84 offset:10240
    ds_read_b64_tr_b16 v[138:139], v84 offset:11264
    ds_read_b64_tr_b16 v[140:141], v85 offset:10240
    ds_read_b64_tr_b16 v[142:143], v85 offset:11264
    s_waitcnt lgkmcnt(4)
    buffer_store_dwordx4 v[128:131], v86, s[36:39], s43 offen sc1
    s_add_u32 s43, s43, s46
    buffer_store_dwordx4 v[132:135], v86, s[36:39], s58 offen sc1
    s_add_u32 s58, s58, s46
    s_waitcnt vmcnt(11)
    ds_read_b64_tr_b16 v[144:145], v84 offset:12288
    ds_read_b64_tr_b16 v[146:147], v84 offset:13312
    ds_read_b64_tr_b16 v[148:149], v85 offset:12288
    ds_read_b64_tr_b16 v[150:151], v85 offset:13312
    s_waitcnt lgkmcnt(4)
    buffer_store_dwordx4 v[136:139], v86, s[36:39], s43 offen sc1
    s_add_u32 s43, s43, s46
    buffer_store_dwordx4 v[140:143], v86, s[36:39], s58 offen sc1
    s_add_u32 s58, s58, s46
    s_waitcnt lgkmcnt(0)
    buffer_store_dwordx4 v[144:147], v86, s[36:39], s43 offen sc1
    s_add_u32 s43, s43, s46
    buffer_store_dwordx4 v[148:151], v86, s[36:39], s58 offen sc1
    s_add_u32 s58, s58, s46
    s_nop 0
    v_dot2_f32_bf16 v92, v96, s48, 0
    v_dot2_f32_bf16 v93, v100, s48, 0
    v_dot2_f32_bf16 v92, v97, s48, v92
    v_dot2_f32_bf16 v93, v101, s48, v93
    v_dot2_f32_bf16 v92, v98, s48, v92
    v_dot2_f32_bf16 v93, v102, s48, v93
    v_dot2_f32_bf16 v92, v99, s48, v92
    v_dot2_f32_bf16 v93, v103, s48, v93
    v_dot2_f32_bf16 v92, v104, s48, v92
    v_dot2_f32_bf16 v93, v108, s48, v93
    v_dot2_f32_bf16 v92, v105, s48, v92
    v_dot2_f32_bf16 v93, v109, s48, v93
    v_dot2_f32_bf16 v92, v106, s48, v92
    v_dot2_f32_bf16 v93, v110, s48, v93
    v_dot2_f32_bf16 v92, v107, s48, v92
    v_dot2_f32_bf16 v93, v111, s48, v93
    v_dot2_f32_bf16 v92, v112, s48, v92
    v_dot2_f32_bf16 v93, v116, s48, v93
    v_dot2_f32_bf16 v92, v113, s48, v92
    v_dot2_f32_bf16 v93, v117, s48, v93
    v_dot2_f32_bf16 v92, v114, s48, v92
    v_dot2_f32_bf16 v93, v118, s48, v93
    v_dot2_f32_bf16 v92, v115, s48, v92
    v_dot2_f32_bf16 v93, v119, s48, v93
    v_dot2_f32_bf16 v92, v120, s48, v92
    v_dot2_f32_bf16 v93, v124, s48, v93
    v_dot2_f32_bf16 v92, v121, s48, v92
    v_dot2_f32_bf16 v93, v125, s48, v93
    v_dot2_f32_bf16 v92, v122, s48, v92
    v_dot2_f32_bf16 v93, v126, s48, v93
    v_dot2_f32_bf16 v92, v123, s48, v92
    v_dot2_f32_bf16 v93, v127, s48, v93
    v_dot2_f32_bf16 v92, v128, s48, v92
    v_dot2_f32_bf16 v93, v132, s48, v93
    v_dot2_f32_bf16 v92, v129, s48, v92
    v_dot2_f32_bf16 v93, v133, s48, v93
    v_dot2_f32_bf16 v92, v130, s48, v92
    v_dot2_f32_bf16 v93, v134, s48, v93
    v_dot2_f32_bf16 v92, v131, s48, v92
    v_dot2_f32_bf16 v93, v135, s48, v93
    v_dot2_f32_bf16 v92, v136, s48, v92
    v_dot2_f32_bf16 v93, v140, s48, v93
    v_dot2_f32_bf16 v92, v137, s48, v92
    v_dot2_f32_bf16 v93, v141, s48, v93
    v_dot2_f32_bf16 v92, v138, s48, v92
    v_dot2_f32_bf16 v93, v142, s48, v93
    v_dot2_f32_bf16 v92, v139, s48, v92
    v_dot2_f32_bf16 v93, v143, s48, v93
    v_dot2_f32_bf16 v92, v144, s48, v92
    v_dot2_f32_bf16 v93, v148, s48, v93
    v_dot2_f32_bf16 v92, v145, s48, v92
    v_dot2_f32_bf16 v93, v149, s48, v93
    v_dot2_f32_bf16 v92, v146, s48, v92
    v_dot2_f32_bf16 v93, v150, s48, v93
    v_dot2_f32_bf16 v92, v147, s48, v92
    v_dot2_f32_bf16 v93, v151, s48, v93
    s_nop 2
    v_permlane32_swap_b32 v92, v93
    v_add_f32 v92, v92, v93
    ds_write_b32 v87, v92 offset:2048
    s_waitcnt lgkmcnt(0)
    s_barrier
    ds_read2st64_b32 v[92:93], v88 offset0:8 offset1:9
    ds_read2st64_b32 v[94:95], v88 offset0:10 offset1:11
    s_waitcnt lgkmcnt(0)
    v_add_f32 v92, v92, v93
    v_add_f32 v94, v94, v95
    v_add_f32 v92, v92, v94
    buffer_store_dword v92, v88, s[36:39], s49 offen sc1
    s_waitcnt vmcnt(0)
    s_barrier
    s_mov_b32 exec_hi, 0
    buffer_atomic_add v72, v3, s[36:39], s11 offen sc1
    s_mov_b64 exec, 1
    buffer_atomic_add v72, off, s[36:39], s51 offset:2048 sc1
    s_mov_b64 exec, -1
    s_endpgm
K_WZ:
    s_mov_b32 s54, 1048576
K_WZ2:
    global_load_dword v3, v89, s[30:31] sc1
    s_sub_u32 s54, s54, 1
    s_cbranch_scc1 K_WZ1
    s_waitcnt vmcnt(0)
    v_cmp_gt_u32 vcc, 32, v3
    s_cbranch_vccnz K_WZ2
    s_branch K_WZ1
.section .rodata,"a"
.p2align 6
.amdhsa_kernel sequential_preLN__ssm_conv_s4d__mixer_s_mlp__prompt_kernel
  .amdhsa_next_free_vgpr 512
  .amdhsa_next_free_sgpr 102
  .amdhsa_accum_offset 256
  .amdhsa_group_segment_fixed_size 0
  .amdhsa_kernarg_size 120
  .amdhsa_user_sgpr_count 2
  .amdhsa_user_sgpr_kernarg_segment_ptr 1
  .amdhsa_system_sgpr_workgroup_id_x 1
.end_amdhsa_kernel
```
